```python
import torch

def _softmax(x, axis=-1):
    return torch.softmax(x, dim=axis)
def _gelu(x):
    return torch.nn.functional.gelu(x, approximate="tanh")
def _silu(x):
    return torch.nn.functional.silu(x)
def _sigmoid(x):
    return torch.sigmoid(x)
def _layernorm(x, axis=-1, eps=1e-5):
    m = x.mean(dim=axis, keepdim=True)
    v = x.var(dim=axis, keepdim=True, unbiased=False)
    return (x - m) / torch.sqrt(v + eps)
def _scatter_add(tgt, idx, src, axis=0):
    return tgt.clone().index_add_(axis, idx, src)
def _segment_sum(src, seg, n):
    out = torch.zeros((n,) + src.shape[1:], dtype=src.dtype)
    return out.index_add_(0, seg, src)
def _pad(x, pw):
    flat = tuple(v for pair in reversed(pw) for v in pair)
    return torch.nn.functional.pad(x, flat)

kernel_name = 'recurrent_scan__linear_attn_block__dense_activation_gelu__prompt'

def setup_inputs():

    _w = (lambda a: (lambda t: t.to(torch.bfloat16) if t.is_floating_point() else t)(torch.as_tensor(a)))
    def _A_setup():
        B, S, D = 1, 2048, 512
        return {
            "x": _w((lambda *s: torch.randn(*s, dtype=torch.bfloat16) * 0.05)(B, S, D)),
            "wqkv": _w((lambda *s: torch.randn(*s, dtype=torch.bfloat16) * 0.2)(D, 3 * D)),
            "wo": _w((lambda *s: torch.randn(*s, dtype=torch.bfloat16) * 0.2)(D, D)),
        }
    _A_in = _A_setup()

    def _B_setup():
        B, S, D, F = 1, 2048, 512, 1376
        return {
            "x": _w((lambda *s: torch.randn(*s, dtype=torch.bfloat16) * 0.05)(B, S, D)),
            "w1": _w((lambda *s: torch.randn(*s, dtype=torch.bfloat16) * 0.4)(D, F) * (D ** -0.5)),
            "b1": _w((lambda *s: torch.randn(*s, dtype=torch.bfloat16) * 12.8)(F) * 0.01),
            "w2": _w((lambda *s: torch.randn(*s, dtype=torch.bfloat16) * 0.2)(F, D) * (F ** -0.5)),
            "b2": _w((lambda *s: torch.randn(*s, dtype=torch.bfloat16) * 3.2)(D) * 0.01),
        }
    _B_in = _B_setup()

    return {
        "A_x": _A_in["x"],
        "A_wqkv": _A_in["wqkv"],
        "A_wo": _A_in["wo"],
        "B_x": _B_in["x"],
        "B_w1": _B_in["w1"],
        "B_b1": _B_in["b1"],
        "B_w2": _B_in["w2"],
        "B_b2": _B_in["b2"],
    }

def reference(A_x, A_wqkv, A_wo, B_x, B_w1, B_b1, B_w2, B_b2):
    def _A_ref(x, wqkv, wo):
        B, S, D = x.shape
        H = 32; Dh = D // H
        qkv = (lambda x, *d: x.permute(*d))((x @ wqkv).reshape(B, S, 3, H, Dh), 2, 0, 3, 1, 4)
        q, k, v = qkv[0], qkv[1], qkv[2]
        phi = lambda t: torch.where(t > 0, t + 1, torch.exp(t)) + 1e-6
        pq, pk = phi(q), phi(k)
        kv = torch.einsum("bhsd,bhse->bhde", pk, v)
        z = torch.einsum("bhsd->bhd", pk)
        num = torch.einsum("bhqd,bhde->bhqe", pq, kv)
        den = torch.einsum("bhqd,bhd->bhq", pq, z)[..., None] + 1e-6
        o = num / den
        return (lambda x, *d: x.permute(*d))(o, 0, 2, 1, 3).reshape(B, S, D) @ wo

    def _B_ref(x, w1, b1, w2, b2):
        h = torch.einsum("bsd,df->bsf", x, w1) + b1
        h = _gelu(h)
        return torch.einsum("bsf,fd->bsd", h, w2) + b2

    x = A_x
    xn = _layernorm(x, axis=-1)
    s = _A_ref(xn, A_wqkv, A_wo)
    g = _silu(_B_ref(xn, B_w1, B_b1, B_w2, B_b2))
    return x + s * g
```

```asm
; @launch grid=(256,1,1) block=(512,1,1) lds=163840
.amdgcn_target "amdgcn-amd-amdhsa--gfx950"
.text
.globl recurrent_scan__linear_attn_block__dense_activation_gelu__prompt_kernel
.p2align 8
.type recurrent_scan__linear_attn_block__dense_activation_gelu__prompt_kernel,@function
recurrent_scan__linear_attn_block__dense_activation_gelu__prompt_kernel:
  s_cmp_ge_u32 s2, 256
  s_cbranch_scc1 L_end
  s_load_dwordx16 s[4:19], s[0:1], 0
  s_load_dwordx4 s[20:23], s[0:1], 64
  s_load_dwordx2 s[24:25], s[0:1], 80
  s_getpc_b64 s[26:27]
L_pc:
  s_bfe_u32 s3, s2, 196611
  s_mul_i32 s3, s3, 40
  v_lshrrev_b32 v3, 6, v0
  v_and_b32 v4, 63, v0
  v_min_u32 v4, 4, v4
  v_mad_u32_u24 v3, v3, 5, v4
  v_add_lshl_u32 v3, v3, s3, 7
  v_min_u32 v3, L_last-L_pc, v3
  global_load_dword v127, v3, s[26:27]
  v_lshrrev_b32 v2, 6, v0
  v_and_b32 v1, 63, v0
  s_and_b32 s75, s2, 3
  v_readfirstlane_b32 s64, v2
  s_bfe_u32 s68, s2, 0x10002
  s_bfe_u32 s69, s2, 0x30003
  s_lshr_b32 s65, s2, 6
  s_lshl_b32 s65, s65, 2
  s_add_u32 s65, s65, s75
  s_lshr_b32 s67, s69, 2
  s_and_b32 s66, s69, 3
  s_lshl_b32 s75, s68, 2
  s_add_u32 s66, s66, s75
  s_lshl_b32 s75, s66, 7
  s_mul_i32 s76, s66, 384
  s_add_u32 s77, s75, 1024
  s_add_u32 s78, s75, 2048
  s_add_u32 s79, s76, 128
  s_add_u32 s80, s76, 256
  s_cmp_eq_u32 s67, 0
  s_movk_i32 s74, 2752
  s_cselect_b32 s74, 3072, s74
  s_cselect_b32 s81, s77, s76
  s_cselect_b32 s82, s78, s79
  s_cselect_b32 s83, s75, s80
  s_cmp_ge_u32 s64, 4
  s_cbranch_scc1 L_loader
  s_bfe_u32 s71, s64, 0x10001
  s_and_b32 s72, s64, 1
  v_and_b32 v2, 31, v1
  v_lshrrev_b32 v3, 5, v1
  v_lshrrev_b32 v4, 4, v1
  v_and_b32 v5, 15, v1
  v_mov_b32 v126, 0
  s_lshl_b32 s75, s68, 3
  s_add_u32 s75, s75, s69
  s_lshl_b32 s75, s75, 3
  s_lshl_b32 s76, s65, 7
  s_add_u32 s75, s75, s76
  s_lshl_b32 s77, s64, 1
  s_add_u32 s75, s75, s77
  v_add_u32 v6, s75, v3
  v_lshlrev_b32 v11, 4, v2
  v_lshl_add_u32 v11, v6, 10, v11
  s_lshl_b32 s77, s65, 3
  s_add_u32 s77, s77, s66
  s_lshl_b32 s78, s74, 2
  s_mul_i32 s77, s77, s78
  s_sub_u32 s78, s78, 4
  s_mul_i32 s79, s64, 24
  v_min_u32 v12, 23, v1
  v_add_lshl_u32 v12, v12, s79, 7
  v_min_u32 v12, s78, v12
  v_add_u32 v97, s77, v12
  s_lshl_b32 s34, s74, 9
  s_mov_b32 s35, 0x00020000
  s_cmp_eq_u32 s67, 0
  s_waitcnt lgkmcnt(0)
  s_cselect_b32 s32, s6, s12
  s_cselect_b32 s33, s7, s13
  s_mov_b32 s28, s4
  s_mov_b32 s29, s5
  s_mov_b32 s30, 2097152
  s_mov_b32 s31, 0x00020000
  buffer_load_dwordx4 v[128:131], v11, s[28:31], 0 offen
  buffer_load_dwordx4 v[132:135], v11, s[28:31], 0 offen offset:512
  buffer_load_dword v127, v97, s[32:35], 0 offen
  s_barrier
  s_lshr_b32 s78, s2, 0
  s_or_b32 s78, s78, s64
  s_cmp_lg_u32 s78, 0
  s_cbranch_scc1 Lnon_1
  s_memrealtime s[86:87]
  s_waitcnt lgkmcnt(0)
  s_mov_b32 s48, s22
  s_mov_b32 s49, s23
  s_mov_b32 s50, 256
  s_mov_b32 s51, 0x00020000
  s_or_b32 s78, s86, 1
  v_mov_b32 v8, s78
  s_mov_b64 exec, 1
  buffer_store_dword v8, v126, s[48:51], 0 offen sc1
  s_mov_b64 exec, -1
Lnon_1:
  s_branch L_compute
L_loader:
  s_and_b32 s85, s64, 3
  v_lshrrev_b32 v2, 3, v1
  v_and_b32 v3, 7, v1
  v_lshrrev_b32 v4, 4, v1
  s_and_b32 s75, s85, 1
  s_lshl_b32 s75, s75, 2
  s_lshl_b32 s76, s85, 3
  v_add_u32 v5, s75, v4
  v_xor_b32 v5, v3, v5
  v_lshlrev_b32 v5, 4, v5
  v_add_u32 v6, s76, v2
  v_lshl_add_u32 v10, v6, 10, v5
  v_add_u32 v11, 32768, v10
  v_add_u32 v12, 65536, v10
  v_add_u32 v13, 98304, v10
  v_and_b32 v7, 1, v4
  v_lshlrev_b32 v7, 2, v7
  v_xor_b32 v7, v3, v7
  v_lshlrev_b32 v7, 4, v7
  v_mul_u32_u24 v8, s74, v6
  s_lshl_b32 s77, s74, 5
  v_mov_b32 v2, 0x80000000
  v_add_u32 v9, s81, v7
  v_cmp_gt_u32 vcc, s74, v9
  v_add_u32 v9, v8, v9
  v_add_u32 v3, s77, v9
  v_cndmask_b32 v14, v2, v9, vcc
  v_cndmask_b32 v15, v2, v3, vcc
  v_add_u32 v9, s82, v7
  v_cmp_gt_u32 vcc, s74, v9
  v_add_u32 v9, v8, v9
  v_add_u32 v3, s77, v9
  v_cndmask_b32 v16, v2, v9, vcc
  v_cndmask_b32 v17, v2, v3, vcc
  v_add_u32 v9, s83, v7
  v_cmp_gt_u32 vcc, s74, v9
  v_add_u32 v9, v8, v9
  v_add_u32 v3, s77, v9
  v_cndmask_b32 v18, v2, v9, vcc
  v_cndmask_b32 v19, v2, v3, vcc
  s_lshl_b32 s85, s85, 10
  s_lshl_b32 s3, s65, 17
  s_lshl_b32 s78, s74, 5
  s_waitcnt lgkmcnt(0)
  s_mov_b32 s28, s4
  s_mov_b32 s29, s5
  s_mov_b32 s30, 2097152
  s_mov_b32 s31, 0x00020000
  s_lshl_b32 s34, s74, 9
  s_mov_b32 s35, 0x00020000
  s_cmp_eq_u32 s67, 0
  s_cselect_b32 s32, s6, s12
  s_cselect_b32 s33, s7, s13
  s_barrier
  s_mul_i32 s27, s78, 0
  s_add_u32 m0, s85, 131072
  s_nop 0
  buffer_load_dwordx4 v14, s[32:35], s27 offen lds
  s_add_u32 m0, s85, 135168
  s_nop 0
  buffer_load_dwordx4 v16, s[32:35], s27 offen lds
  s_add_u32 s26, s3, 0
  s_add_u32 m0, s85, 0
  s_nop 0
  buffer_load_dwordx4 v10, s[28:31], s26 offen lds
  s_add_u32 m0, s85, 4096
  s_nop 0
  buffer_load_dwordx4 v11, s[28:31], s26 offen lds
  s_add_u32 s26, s3, 0
  s_add_u32 m0, s85, 8192
  s_nop 0
  buffer_load_dwordx4 v12, s[28:31], s26 offen lds
  s_add_u32 m0, s85, 12288
  s_nop 0
  buffer_load_dwordx4 v13, s[28:31], s26 offen lds
  s_mul_i32 s27, s78, 1
  s_add_u32 m0, s85, 139264
  s_nop 0
  buffer_load_dwordx4 v14, s[32:35], s27 offen lds
  s_add_u32 m0, s85, 143360
  s_nop 0
  buffer_load_dwordx4 v16, s[32:35], s27 offen lds
  s_lshr_b32 s76, s2, 6
  s_mul_i32 s76, s76, 1
  s_add_u32 s76, s76, s69
  s_mul_i32 s75, s76, 128
  s_lshr_b32 s75, s75, 8
  s_mul_i32 s75, s75, 2
  s_sub_u32 s76, s76, s75
  s_add_u32 s57, s76, 1
  s_add_u32 s58, s57, 1
  s_cmp_eq_u32 s58, 3
  s_cselect_b32 s58, 1, s58
  s_lshr_b32 s76, s2, 6
  s_mul_i32 s76, s76, 1
  s_add_u32 s76, s76, s69
  s_mul_i32 s75, s76, 128
  s_lshr_b32 s75, s75, 8
  s_mul_i32 s75, s75, 2
  s_sub_u32 s76, s76, s75
  s_add_u32 s59, s76, 3
  s_add_u32 s60, s59, 1
  s_cmp_eq_u32 s60, 5
  s_cselect_b32 s60, 3, s60
  s_lshr_b32 s76, s2, 6
  s_mul_i32 s76, s76, 1
  s_add_u32 s76, s76, s69
  s_mul_i32 s75, s76, 86
  s_lshr_b32 s75, s75, 8
  s_mul_i32 s75, s75, 3
  s_sub_u32 s76, s76, s75
  s_add_u32 s61, s76, 5
  s_add_u32 s62, s61, 1
  s_cmp_eq_u32 s62, 8
  s_cselect_b32 s62, 5, s62
  s_add_u32 s63, s62, 1
  s_cmp_eq_u32 s63, 8
  s_cselect_b32 s63, 5, s63
  s_lshl_b32 s26, s57, 7
  s_add_u32 s26, s26, s3
  s_add_u32 m0, s85, 16384
  s_nop 0
  buffer_load_dwordx4 v10, s[28:31], s26 offen lds
  s_add_u32 m0, s85, 20480
  s_nop 0
  buffer_load_dwordx4 v11, s[28:31], s26 offen lds
  s_mov_b32 s36, s16
  s_mov_b32 s37, s17
  s_mov_b32 s38, 1409024
  s_mov_b32 s39, 0x00020000
  s_mov_b32 s40, s8
  s_mov_b32 s41, s9
  s_mov_b32 s42, 524288
  s_mov_b32 s43, 0x00020000
  s_mov_b32 s44, s24
  s_mov_b32 s45, s25
  s_mov_b32 s46, 268435456
  s_mov_b32 s47, 0x00020000
  s_lshl_b32 s75, s69, 7
  v_lshl_add_u32 v20, v6, 10, v7
  v_add_u32 v20, s75, v20
  v_lshl_add_u32 v24, v1, 4, s85
  v_add_u32 v25, 65536, v24
  v_add_u32 v26, 131072, v24
  s_lshr_b32 s75, s85, 8
  s_add_u32 s75, s75, 155776
  v_mov_b32 v28, s75
  v_and_b32 v29, 3, v1
  v_lshlrev_b32 v29, 2, v29
  v_add_u32 v29, 155792, v29
  s_waitcnt vmcnt(4)
  s_barrier
  s_lshl_b32 s27, s57, 1
  s_mul_i32 s27, s27, s78
  s_add_u32 m0, s85, 147456
  s_nop 0
  buffer_load_dwordx4 v14, s[32:35], s27 offen lds
  s_add_u32 m0, s85, 151552
  s_nop 0
  buffer_load_dwordx4 v16, s[32:35], s27 offen lds
  s_lshl_b32 s26, s57, 7
  s_add_u32 s26, s26, s3
  s_add_u32 m0, s85, 24576
  s_nop 0
  buffer_load_dwordx4 v12, s[28:31], s26 offen lds
  s_add_u32 m0, s85, 28672
  s_nop 0
  buffer_load_dwordx4 v13, s[28:31], s26 offen lds
  s_waitcnt vmcnt(6)
  s_barrier
  s_lshl_b32 s27, s57, 1
  s_add_u32 s27, s27, 1
  s_mul_i32 s27, s27, s78
  s_add_u32 m0, s85, 131072
  s_nop 0
  buffer_load_dwordx4 v14, s[32:35], s27 offen lds
  s_add_u32 m0, s85, 135168
  s_nop 0
  buffer_load_dwordx4 v16, s[32:35], s27 offen lds
  s_lshl_b32 s26, s58, 7
  s_add_u32 s26, s26, s3
  s_add_u32 m0, s85, 32768
  s_nop 0
  buffer_load_dwordx4 v10, s[28:31], s26 offen lds
  s_add_u32 m0, s85, 36864
  s_nop 0
  buffer_load_dwordx4 v11, s[28:31], s26 offen lds
  s_waitcnt vmcnt(4)
  s_barrier
  s_lshl_b32 s27, s58, 1
  s_mul_i32 s27, s27, s78
  s_add_u32 m0, s85, 139264
  s_nop 0
  buffer_load_dwordx4 v14, s[32:35], s27 offen lds
  s_add_u32 m0, s85, 143360
  s_nop 0
  buffer_load_dwordx4 v16, s[32:35], s27 offen lds
  s_lshl_b32 s26, s58, 7
  s_add_u32 s26, s26, s3
  s_add_u32 m0, s85, 40960
  s_nop 0
  buffer_load_dwordx4 v12, s[28:31], s26 offen lds
  s_add_u32 m0, s85, 45056
  s_nop 0
  buffer_load_dwordx4 v13, s[28:31], s26 offen lds
  s_waitcnt vmcnt(6)
  s_barrier
  s_lshl_b32 s27, s58, 1
  s_add_u32 s27, s27, 1
  s_mul_i32 s27, s27, s78
  s_add_u32 m0, s85, 147456
  s_nop 0
  buffer_load_dwordx4 v14, s[32:35], s27 offen lds
  s_add_u32 m0, s85, 151552
  s_nop 0
  buffer_load_dwordx4 v16, s[32:35], s27 offen lds
  s_lshl_b32 s26, s59, 7
  s_add_u32 s26, s26, s3
  s_add_u32 m0, s85, 49152
  s_nop 0
  buffer_load_dwordx4 v10, s[28:31], s26 offen lds
  s_add_u32 m0, s85, 53248
  s_nop 0
  buffer_load_dwordx4 v11, s[28:31], s26 offen lds
  s_waitcnt vmcnt(4)
  s_barrier
  s_lshl_b32 s27, s59, 1
  s_mul_i32 s27, s27, s78
  s_add_u32 m0, s85, 131072
  s_nop 0
  buffer_load_dwordx4 v14, s[32:35], s27 offen lds
  s_add_u32 m0, s85, 135168
  s_nop 0
  buffer_load_dwordx4 v16, s[32:35], s27 offen lds
  s_lshl_b32 s26, s59, 7
  s_add_u32 s26, s26, s3
  s_add_u32 m0, s85, 57344
  s_nop 0
  buffer_load_dwordx4 v12, s[28:31], s26 offen lds
  s_add_u32 m0, s85, 61440
  s_nop 0
  buffer_load_dwordx4 v13, s[28:31], s26 offen lds
  s_waitcnt vmcnt(6)
  s_barrier
  s_lshl_b32 s27, s59, 1
  s_add_u32 s27, s27, 1
  s_mul_i32 s27, s27, s78
  s_add_u32 m0, s85, 139264
  s_nop 0
  buffer_load_dwordx4 v14, s[32:35], s27 offen lds
  s_add_u32 m0, s85, 143360
  s_nop 0
  buffer_load_dwordx4 v16, s[32:35], s27 offen lds
  s_lshl_b32 s26, s60, 7
  s_add_u32 s26, s26, s3
  s_add_u32 m0, s85, 65536
  s_nop 0
  buffer_load_dwordx4 v10, s[28:31], s26 offen lds
  s_add_u32 m0, s85, 69632
  s_nop 0
  buffer_load_dwordx4 v11, s[28:31], s26 offen lds
  s_waitcnt vmcnt(4)
  s_barrier
  s_lshl_b32 s27, s60, 1
  s_mul_i32 s27, s27, s78
  s_add_u32 m0, s85, 147456
  s_nop 0
  buffer_load_dwordx4 v14, s[32:35], s27 offen lds
  s_add_u32 m0, s85, 151552
  s_nop 0
  buffer_load_dwordx4 v16, s[32:35], s27 offen lds
  s_lshl_b32 s26, s60, 7
  s_add_u32 s26, s26, s3
  s_add_u32 m0, s85, 73728
  s_nop 0
  buffer_load_dwordx4 v12, s[28:31], s26 offen lds
  s_add_u32 m0, s85, 77824
  s_nop 0
  buffer_load_dwordx4 v13, s[28:31], s26 offen lds
  s_waitcnt vmcnt(6)
  s_barrier
  s_lshl_b32 s27, s60, 1
  s_add_u32 s27, s27, 1
  s_mul_i32 s27, s27, s78
  s_add_u32 m0, s85, 131072
  s_nop 0
  buffer_load_dwordx4 v14, s[32:35], s27 offen lds
  s_add_u32 m0, s85, 135168
  s_nop 0
  buffer_load_dwordx4 v16, s[32:35], s27 offen lds
  s_lshl_b32 s26, s61, 7
  s_add_u32 s26, s26, s3
  s_add_u32 m0, s85, 81920
  s_nop 0
  buffer_load_dwordx4 v10, s[28:31], s26 offen lds
  s_add_u32 m0, s85, 86016
  s_nop 0
  buffer_load_dwordx4 v11, s[28:31], s26 offen lds
  s_waitcnt vmcnt(4)
  s_barrier
  s_lshl_b32 s27, s61, 1
  s_mul_i32 s27, s27, s78
  s_add_u32 m0, s85, 139264
  s_nop 0
  buffer_load_dwordx4 v14, s[32:35], s27 offen lds
  s_add_u32 m0, s85, 143360
  s_nop 0
  buffer_load_dwordx4 v16, s[32:35], s27 offen lds
  s_lshl_b32 s26, s61, 7
  s_add_u32 s26, s26, s3
  s_add_u32 m0, s85, 90112
  s_nop 0
  buffer_load_dwordx4 v12, s[28:31], s26 offen lds
  s_add_u32 m0, s85, 94208
  s_nop 0
  buffer_load_dwordx4 v13, s[28:31], s26 offen lds
  s_waitcnt vmcnt(6)
  s_barrier
  s_lshl_b32 s27, s61, 1
  s_add_u32 s27, s27, 1
  s_mul_i32 s27, s27, s78
  s_add_u32 m0, s85, 147456
  s_nop 0
  buffer_load_dwordx4 v14, s[32:35], s27 offen lds
  s_add_u32 m0, s85, 151552
  s_nop 0
  buffer_load_dwordx4 v16, s[32:35], s27 offen lds
  s_lshl_b32 s26, s62, 7
  s_add_u32 s26, s26, s3
  s_add_u32 m0, s85, 98304
  s_nop 0
  buffer_load_dwordx4 v10, s[28:31], s26 offen lds
  s_add_u32 m0, s85, 102400
  s_nop 0
  buffer_load_dwordx4 v11, s[28:31], s26 offen lds
  s_waitcnt vmcnt(4)
  s_barrier
  s_lshl_b32 s27, s62, 1
  s_mul_i32 s27, s27, s78
  s_add_u32 m0, s85, 131072
  s_nop 0
  buffer_load_dwordx4 v14, s[32:35], s27 offen lds
  s_add_u32 m0, s85, 135168
  s_nop 0
  buffer_load_dwordx4 v16, s[32:35], s27 offen lds
  s_lshl_b32 s26, s62, 7
  s_add_u32 s26, s26, s3
  s_add_u32 m0, s85, 106496
  s_nop 0
  buffer_load_dwordx4 v12, s[28:31], s26 offen lds
  s_add_u32 m0, s85, 110592
  s_nop 0
  buffer_load_dwordx4 v13, s[28:31], s26 offen lds
  s_waitcnt vmcnt(6)
  s_barrier
  s_lshl_b32 s27, s62, 1
  s_add_u32 s27, s27, 1
  s_mul_i32 s27, s27, s78
  s_add_u32 m0, s85, 139264
  s_nop 0
  buffer_load_dwordx4 v14, s[32:35], s27 offen lds
  s_add_u32 m0, s85, 143360
  s_nop 0
  buffer_load_dwordx4 v16, s[32:35], s27 offen lds
  s_lshl_b32 s26, s63, 7
  s_add_u32 s26, s26, s3
  s_add_u32 m0, s85, 114688
  s_nop 0
  buffer_load_dwordx4 v10, s[28:31], s26 offen lds
  s_add_u32 m0, s85, 118784
  s_nop 0
  buffer_load_dwordx4 v11, s[28:31], s26 offen lds
  s_cmp_eq_u32 s67, 0
  s_cbranch_scc0 L_loadB
  s_waitcnt vmcnt(4)
  s_barrier
  s_lshl_b32 s27, s63, 1
  s_mul_i32 s27, s27, s78
  s_add_u32 m0, s85, 147456
  s_nop 0
  buffer_load_dwordx4 v14, s[32:35], s27 offen lds
  s_add_u32 m0, s85, 151552
  s_nop 0
  buffer_load_dwordx4 v16, s[32:35], s27 offen lds
  s_lshl_b32 s26, s63, 7
  s_add_u32 s26, s26, s3
  s_add_u32 m0, s85, 122880
  s_nop 0
  buffer_load_dwordx4 v12, s[28:31], s26 offen lds
  s_add_u32 m0, s85, 126976
  s_nop 0
  buffer_load_dwordx4 v13, s[28:31], s26 offen lds
  s_waitcnt vmcnt(6)
  s_barrier
  s_lshl_b32 s27, s63, 1
  s_add_u32 s27, s27, 1
  s_mul_i32 s27, s27, s78
  s_add_u32 m0, s85, 131072
  s_nop 0
  buffer_load_dwordx4 v14, s[32:35], s27 offen lds
  s_add_u32 m0, s85, 135168
  s_nop 0
  buffer_load_dwordx4 v16, s[32:35], s27 offen lds
  s_waitcnt vmcnt(2)
  s_barrier
  s_mul_i32 s27, s78, 0
  s_add_u32 m0, s85, 139264
  s_nop 0
  buffer_load_dwordx4 v18, s[32:35], s27 offen lds
  s_add_u32 m0, s85, 143360
  s_nop 0
  buffer_load_dwordx4 v19, s[32:35], s27 offen lds
  s_waitcnt vmcnt(2)
  s_barrier
  s_lshl_b32 s27, s57, 1
  s_mul_i32 s27, s27, s78
  s_add_u32 m0, s85, 147456
  s_nop 0
  buffer_load_dwordx4 v18, s[32:35], s27 offen lds
  s_add_u32 m0, s85, 151552
  s_nop 0
  buffer_load_dwordx4 v19, s[32:35], s27 offen lds
  s_mov_b32 s80, 0
  buffer_load_dwordx4 v[32:35], v20, s[36:39], s80 offen
  s_mov_b32 s80, 32768
  buffer_load_dwordx4 v[36:39], v20, s[36:39], s80 offen
  s_mov_b32 s80, 196608
  buffer_load_dwordx4 v[40:43], v20, s[36:39], s80 offen
  s_mov_b32 s80, 229376
  buffer_load_dwordx4 v[44:47], v20, s[36:39], s80 offen
  s_mov_b32 s80, 393216
  buffer_load_dwordx4 v[48:51], v20, s[36:39], s80 offen
  s_waitcnt vmcnt(7)
  s_barrier
  s_lshl_b32 s27, s58, 1
  s_mul_i32 s27, s27, s78
  s_add_u32 m0, s85, 131072
  s_nop 0
  buffer_load_dwordx4 v18, s[32:35], s27 offen lds
  s_add_u32 m0, s85, 135168
  s_nop 0
  buffer_load_dwordx4 v19, s[32:35], s27 offen lds
  s_mov_b32 s80, 425984
  buffer_load_dwordx4 v[52:55], v20, s[36:39], s80 offen
  s_mov_b32 s80, 589824
  buffer_load_dwordx4 v[56:59], v20, s[36:39], s80 offen
  s_mov_b32 s80, 622592
  buffer_load_dwordx4 v[60:63], v20, s[36:39], s80 offen
  s_mov_b32 s80, 786432
  buffer_load_dwordx4 v[64:67], v20, s[36:39], s80 offen
  s_mov_b32 s80, 819200
  buffer_load_dwordx4 v[68:71], v20, s[36:39], s80 offen
  s_mov_b32 s80, 983040
  buffer_load_dwordx4 v[72:75], v20, s[36:39], s80 offen
  s_mov_b32 s80, 1015808
  buffer_load_dwordx4 v[76:79], v20, s[36:39], s80 offen
  s_mov_b32 s80, 1179648
  buffer_load_dwordx4 v[80:83], v20, s[36:39], s80 offen
  s_mov_b32 s80, 1212416
  buffer_load_dwordx4 v[84:87], v20, s[36:39], s80 offen
  s_mov_b32 s80, 1376256
  buffer_load_dwordx4 v[88:91], v20, s[36:39], s80 offen
  s_mov_b32 s80, 65536
  buffer_load_dwordx4 v[92:95], v20, s[36:39], s80 offen
  s_mov_b32 s80, 98304
  buffer_load_dwordx4 v[96:99], v20, s[36:39], s80 offen
  s_mov_b32 s80, 262144
  buffer_load_dwordx4 v[100:103], v20, s[36:39], s80 offen
  s_mov_b32 s80, 294912
  buffer_load_dwordx4 v[104:107], v20, s[36:39], s80 offen
  s_mov_b32 s80, 458752
  buffer_load_dwordx4 v[108:111], v20, s[36:39], s80 offen
  s_mov_b32 s80, 491520
  buffer_load_dwordx4 v[112:115], v20, s[36:39], s80 offen
  s_mov_b32 s80, 655360
  buffer_load_dwordx4 v[116:119], v20, s[36:39], s80 offen
  s_mov_b32 s80, 688128
  buffer_load_dwordx4 v[120:123], v20, s[36:39], s80 offen
  s_mov_b32 s80, 851968
  buffer_load_dwordx4 v[124:127], v20, s[36:39], s80 offen
  s_mov_b32 s80, 884736
  buffer_load_dwordx4 v[128:131], v20, s[36:39], s80 offen
  s_waitcnt vmcnt(27)
  s_barrier
  s_lshl_b32 s27, s59, 1
  s_mul_i32 s27, s27, s78
  s_add_u32 m0, s85, 139264
  s_nop 0
  buffer_load_dwordx4 v18, s[32:35], s27 offen lds
  s_add_u32 m0, s85, 143360
  s_nop 0
  buffer_load_dwordx4 v19, s[32:35], s27 offen lds
  s_mov_b32 s80, 1048576
  buffer_load_dwordx4 v[132:135], v20, s[36:39], s80 offen
  s_mov_b32 s80, 1081344
  buffer_load_dwordx4 v[136:139], v20, s[36:39], s80 offen
  s_mov_b32 s80, 1245184
  buffer_load_dwordx4 v[140:143], v20, s[36:39], s80 offen
  s_mov_b32 s80, 1277952
  buffer_load_dwordx4 v[144:147], v20, s[36:39], s80 offen
  s_mov_b32 s80, 131072
  buffer_load_dwordx4 v[148:151], v20, s[36:39], s80 offen
  s_waitcnt vmcnt(27)
  s_barrier
  s_lshl_b32 s27, s60, 1
  s_mul_i32 s27, s27, s78
  s_add_u32 m0, s85, 147456
  s_nop 0
  buffer_load_dwordx4 v18, s[32:35], s27 offen lds
  s_add_u32 m0, s85, 151552
  s_nop 0
  buffer_load_dwordx4 v19, s[32:35], s27 offen lds
  s_mov_b32 s80, 163840
  buffer_load_dwordx4 v[152:155], v20, s[36:39], s80 offen
  s_mov_b32 s80, 327680
  buffer_load_dwordx4 v[156:159], v20, s[36:39], s80 offen
  s_mov_b32 s80, 360448
  buffer_load_dwordx4 v[160:163], v20, s[36:39], s80 offen
  s_mov_b32 s80, 524288
  buffer_load_dwordx4 v[164:167], v20, s[36:39], s80 offen
  s_waitcnt vmcnt(11)
  s_barrier
  s_lshl_b32 s27, s61, 1
  s_mul_i32 s27, s27, s78
  s_add_u32 m0, s85, 131072
  s_nop 0
  buffer_load_dwordx4 v18, s[32:35], s27 offen lds
  s_add_u32 m0, s85, 135168
  s_nop 0
  buffer_load_dwordx4 v19, s[32:35], s27 offen lds
  s_mov_b32 s80, 557056
  buffer_load_dwordx4 v[168:171], v20, s[36:39], s80 offen
  s_mov_b32 s80, 950272
  buffer_load_dwordx4 v[172:175], v20, s[36:39], s80 offen
  s_mov_b32 s80, 1114112
  buffer_load_dwordx4 v[176:179], v20, s[36:39], s80 offen
  s_mov_b32 s80, 1146880
  buffer_load_dwordx4 v[180:183], v20, s[36:39], s80 offen
  s_mov_b32 s80, 1310720
  buffer_load_dwordx4 v[184:187], v20, s[36:39], s80 offen
  s_waitcnt vmcnt(11)
  s_barrier
  s_lshl_b32 s27, s62, 1
  s_mul_i32 s27, s27, s78
  s_add_u32 m0, s85, 139264
  s_nop 0
  buffer_load_dwordx4 v18, s[32:35], s27 offen lds
  s_add_u32 m0, s85, 143360
  s_nop 0
  buffer_load_dwordx4 v19, s[32:35], s27 offen lds
  s_mov_b32 s80, 1343488
  buffer_load_dwordx4 v[188:191], v20, s[36:39], s80 offen
  s_mov_b32 s80, 0
  buffer_load_dwordx4 v[192:195], v20, s[40:43], s80 offen
  s_mov_b32 s80, 32768
  buffer_load_dwordx4 v[196:199], v20, s[40:43], s80 offen
  s_mov_b32 s80, 65536
  buffer_load_dwordx4 v[200:203], v20, s[40:43], s80 offen
  s_waitcnt vmcnt(11)
  s_barrier
  s_lshl_b32 s27, s63, 1
  s_mul_i32 s27, s27, s78
  s_add_u32 m0, s85, 147456
  s_nop 0
  buffer_load_dwordx4 v18, s[32:35], s27 offen lds
  s_add_u32 m0, s85, 151552
  s_nop 0
  buffer_load_dwordx4 v19, s[32:35], s27 offen lds
  s_mov_b32 s80, 98304
  buffer_load_dwordx4 v[204:207], v20, s[40:43], s80 offen
  s_mov_b32 s80, 131072
  buffer_load_dwordx4 v[208:211], v20, s[40:43], s80 offen
  s_mov_b32 s80, 163840
  buffer_load_dwordx4 v[212:215], v20, s[40:43], s80 offen
  s_mov_b32 s80, 196608
  buffer_load_dwordx4 v[216:219], v20, s[40:43], s80 offen
  s_mov_b32 s80, 229376
  buffer_load_dwordx4 v[220:223], v20, s[40:43], s80 offen
  s_waitcnt vmcnt(11)
  s_barrier
  s_mov_b32 s80, 262144
  buffer_load_dwordx4 v[224:227], v20, s[40:43], s80 offen
  s_mov_b32 s80, 294912
  buffer_load_dwordx4 v[228:231], v20, s[40:43], s80 offen
  s_mov_b32 s80, 327680
  buffer_load_dwordx4 v[232:235], v20, s[40:43], s80 offen
  s_mov_b32 s80, 360448
  buffer_load_dwordx4 v[236:239], v20, s[40:43], s80 offen
  s_waitcnt vmcnt(9)
  s_barrier
  s_mov_b32 s80, 393216
  buffer_load_dwordx4 v[240:243], v20, s[40:43], s80 offen
  s_mov_b32 s80, 425984
  buffer_load_dwordx4 v[244:247], v20, s[40:43], s80 offen
  s_mov_b32 s80, 458752
  buffer_load_dwordx4 v[248:251], v20, s[40:43], s80 offen
  s_mov_b32 s80, 491520
  buffer_load_dwordx4 v[252:255], v20, s[40:43], s80 offen
  s_barrier
  s_add_u32 m0, s85, 143360
  s_mov_b32 s80, 720896
  buffer_load_dwordx4 v20, s[36:39], s80 offen lds
  s_add_u32 m0, s85, 147456
  s_mov_b32 s80, 753664
  buffer_load_dwordx4 v20, s[36:39], s80 offen lds
  s_add_u32 m0, s85, 151552
  s_mov_b32 s80, 917504
  buffer_load_dwordx4 v20, s[36:39], s80 offen lds
  ds_write_b128 v24, v[32:35] offset:0
  ds_write_b128 v24, v[36:39] offset:4096
  ds_write_b128 v24, v[40:43] offset:8192
  ds_write_b128 v24, v[44:47] offset:12288
  ds_write_b128 v24, v[48:51] offset:16384
  ds_write_b128 v24, v[52:55] offset:20480
  ds_write_b128 v24, v[56:59] offset:24576
  ds_write_b128 v24, v[60:63] offset:28672
  v_mov_b32 v22, 1
  ds_write_b32 v28, v22
  ds_write_b128 v24, v[64:67] offset:32768
  ds_write_b128 v24, v[68:71] offset:36864
  ds_write_b128 v24, v[72:75] offset:40960
  ds_write_b128 v24, v[76:79] offset:45056
  ds_write_b128 v24, v[80:83] offset:49152
  ds_write_b128 v24, v[84:87] offset:53248
  ds_write_b128 v24, v[88:91] offset:57344
  ds_write_b128 v24, v[92:95] offset:61440
  ds_write_b128 v25, v[96:99] offset:0
  ds_write_b128 v25, v[100:103] offset:4096
  ds_write_b128 v25, v[104:107] offset:8192
  ds_write_b128 v25, v[108:111] offset:12288
  ds_write_b128 v25, v[112:115] offset:16384
  ds_write_b128 v25, v[116:119] offset:20480
  ds_write_b128 v25, v[120:123] offset:24576
  v_mov_b32 v22, 2
  ds_write_b32 v28, v22
  ds_write_b128 v25, v[124:127] offset:28672
  ds_write_b128 v25, v[128:131] offset:32768
  ds_write_b128 v25, v[132:135] offset:36864
  ds_write_b128 v25, v[136:139] offset:40960
  ds_write_b128 v25, v[140:143] offset:45056
  ds_write_b128 v25, v[144:147] offset:49152
  ds_write_b128 v25, v[148:151] offset:53248
  ds_write_b128 v25, v[152:155] offset:57344
  ds_write_b128 v25, v[156:159] offset:61440
  ds_write_b128 v26, v[160:163] offset:0
  ds_write_b128 v26, v[164:167] offset:4096
  ds_write_b128 v26, v[168:171] offset:8192
  s_waitcnt vmcnt(0)
  v_mov_b32 v22, 3
  ds_write_b32 v28, v22
  s_mov_b32 s84, 0
Ldw_2:
  ds_read_b32 v21, v29
  s_add_u32 s84, s84, 1
  s_cmp_gt_u32 s84, 2097152
  s_waitcnt lgkmcnt(0)
  s_cbranch_scc1 Ldwx_3
  v_cmp_gt_u32 vcc, 2, v21
  s_cbranch_vccnz Ldw_2
Ldwx_3:
  ds_write_b128 v24, v[172:175] offset:0
  ds_write_b128 v24, v[176:179] offset:4096
  ds_write_b128 v24, v[180:183] offset:8192
  ds_write_b128 v24, v[184:187] offset:12288
  ds_write_b128 v24, v[188:191] offset:16384
  ds_write_b128 v24, v[192:195] offset:20480
  ds_write_b128 v24, v[196:199] offset:24576
  v_mov_b32 v22, 4
  ds_write_b32 v28, v22
  s_mov_b32 s84, 0
Ldw_4:
  ds_read_b32 v21, v29
  s_add_u32 s84, s84, 1
  s_cmp_gt_u32 s84, 2097152
  s_waitcnt lgkmcnt(0)
  s_cbranch_scc1 Ldwx_5
  v_cmp_gt_u32 vcc, 3, v21
  s_cbranch_vccnz Ldw_4
Ldwx_5:
  ds_write_b128 v24, v[200:203] offset:28672
  ds_write_b128 v24, v[204:207] offset:32768
  ds_write_b128 v24, v[208:211] offset:36864
  ds_write_b128 v24, v[212:215] offset:40960
  ds_write_b128 v24, v[216:219] offset:45056
  ds_write_b128 v24, v[220:223] offset:49152
  ds_write_b128 v24, v[224:227] offset:53248
  ds_write_b128 v24, v[228:231] offset:57344
  ds_write_b128 v24, v[232:235] offset:61440
  ds_write_b128 v25, v[236:239] offset:0
  v_mov_b32 v22, 5
  ds_write_b32 v28, v22
  s_mov_b32 s84, 0
Ldw_6:
  ds_read_b32 v21, v29
  s_add_u32 s84, s84, 1
  s_cmp_gt_u32 s84, 2097152
  s_waitcnt lgkmcnt(0)
  s_cbranch_scc1 Ldwx_7
  v_cmp_gt_u32 vcc, 4, v21
  s_cbranch_vccnz Ldw_6
Ldwx_7:
  ds_write_b128 v25, v[240:243] offset:4096
  ds_write_b128 v25, v[244:247] offset:8192
  ds_write_b128 v25, v[248:251] offset:12288
  ds_write_b128 v25, v[252:255] offset:16384
  v_mov_b32 v22, 6
  ds_write_b32 v28, v22
  s_waitcnt lgkmcnt(0)
  s_endpgm
L_loadB:
  s_waitcnt vmcnt(4)
  s_barrier
  s_lshl_b32 s27, s63, 1
  s_mul_i32 s27, s27, s78
  s_add_u32 m0, s85, 147456
  s_nop 0
  buffer_load_dwordx4 v14, s[32:35], s27 offen lds
  s_add_u32 m0, s85, 151552
  s_nop 0
  buffer_load_dwordx4 v16, s[32:35], s27 offen lds
  s_lshl_b32 s26, s63, 7
  s_add_u32 s26, s26, s3
  s_add_u32 m0, s85, 122880
  s_nop 0
  buffer_load_dwordx4 v12, s[28:31], s26 offen lds
  s_add_u32 m0, s85, 126976
  s_nop 0
  buffer_load_dwordx4 v13, s[28:31], s26 offen lds
  s_waitcnt vmcnt(6)
  s_barrier
  s_lshl_b32 s27, s63, 1
  s_add_u32 s27, s27, 1
  s_mul_i32 s27, s27, s78
  s_add_u32 m0, s85, 131072
  s_nop 0
  buffer_load_dwordx4 v14, s[32:35], s27 offen lds
  s_add_u32 m0, s85, 135168
  s_nop 0
  buffer_load_dwordx4 v16, s[32:35], s27 offen lds
  s_waitcnt vmcnt(2)
  s_barrier
  s_mul_i32 s27, s78, 0
  s_add_u32 m0, s85, 139264
  s_nop 0
  buffer_load_dwordx4 v18, s[32:35], s27 offen lds
  s_add_u32 m0, s85, 143360
  s_nop 0
  buffer_load_dwordx4 v19, s[32:35], s27 offen lds
  s_mov_b32 s80, 0
  buffer_load_dwordx4 v[32:35], v20, s[36:39], s80 offen
  s_mov_b32 s80, 32768
  buffer_load_dwordx4 v[36:39], v20, s[36:39], s80 offen
  s_mov_b32 s80, 196608
  buffer_load_dwordx4 v[40:43], v20, s[36:39], s80 offen
  s_mov_b32 s80, 229376
  buffer_load_dwordx4 v[44:47], v20, s[36:39], s80 offen
  s_waitcnt vmcnt(6)
  s_barrier
  s_lshl_b32 s27, s57, 1
  s_mul_i32 s27, s27, s78
  s_add_u32 m0, s85, 147456
  s_nop 0
  buffer_load_dwordx4 v18, s[32:35], s27 offen lds
  s_add_u32 m0, s85, 151552
  s_nop 0
  buffer_load_dwordx4 v19, s[32:35], s27 offen lds
  s_mov_b32 s80, 393216
  buffer_load_dwordx4 v[48:51], v20, s[36:39], s80 offen
  s_mov_b32 s80, 425984
  buffer_load_dwordx4 v[52:55], v20, s[36:39], s80 offen
  s_mov_b32 s80, 589824
  buffer_load_dwordx4 v[56:59], v20, s[36:39], s80 offen
  s_mov_b32 s80, 622592
  buffer_load_dwordx4 v[60:63], v20, s[36:39], s80 offen
  s_waitcnt vmcnt(10)
  s_barrier
  s_lshl_b32 s27, s58, 1
  s_mul_i32 s27, s27, s78
  s_add_u32 m0, s85, 131072
  s_nop 0
  buffer_load_dwordx4 v18, s[32:35], s27 offen lds
  s_add_u32 m0, s85, 135168
  s_nop 0
  buffer_load_dwordx4 v19, s[32:35], s27 offen lds
  s_mov_b32 s80, 786432
  buffer_load_dwordx4 v[64:67], v20, s[36:39], s80 offen
  s_mov_b32 s80, 819200
  buffer_load_dwordx4 v[68:71], v20, s[36:39], s80 offen
  s_mov_b32 s80, 983040
  buffer_load_dwordx4 v[72:75], v20, s[36:39], s80 offen
  s_mov_b32 s80, 1015808
  buffer_load_dwordx4 v[76:79], v20, s[36:39], s80 offen
  s_waitcnt vmcnt(10)
  s_barrier
  s_lshl_b32 s27, s59, 1
  s_mul_i32 s27, s27, s78
  s_add_u32 m0, s85, 139264
  s_nop 0
  buffer_load_dwordx4 v18, s[32:35], s27 offen lds
  s_add_u32 m0, s85, 143360
  s_nop 0
  buffer_load_dwordx4 v19, s[32:35], s27 offen lds
  s_mov_b32 s80, 1179648
  buffer_load_dwordx4 v[80:83], v20, s[36:39], s80 offen
  s_mov_b32 s80, 1212416
  buffer_load_dwordx4 v[84:87], v20, s[36:39], s80 offen
  s_mov_b32 s80, 1376256
  buffer_load_dwordx4 v[88:91], v20, s[36:39], s80 offen
  s_waitcnt vmcnt(9)
  s_barrier
  s_lshl_b32 s27, s60, 1
  s_mul_i32 s27, s27, s78
  s_add_u32 m0, s85, 147456
  s_nop 0
  buffer_load_dwordx4 v18, s[32:35], s27 offen lds
  s_add_u32 m0, s85, 151552
  s_nop 0
  buffer_load_dwordx4 v19, s[32:35], s27 offen lds
  s_mov_b32 s80, 65536
  buffer_load_dwordx4 v[92:95], v20, s[36:39], s80 offen
  s_mov_b32 s80, 98304
  buffer_load_dwordx4 v[96:99], v20, s[36:39], s80 offen
  s_mov_b32 s80, 262144
  buffer_load_dwordx4 v[100:103], v20, s[36:39], s80 offen
  s_mov_b32 s80, 294912
  buffer_load_dwordx4 v[104:107], v20, s[36:39], s80 offen
  s_waitcnt vmcnt(9)
  s_barrier
  s_lshl_b32 s27, s61, 1
  s_mul_i32 s27, s27, s78
  s_add_u32 m0, s85, 131072
  s_nop 0
  buffer_load_dwordx4 v18, s[32:35], s27 offen lds
  s_add_u32 m0, s85, 135168
  s_nop 0
  buffer_load_dwordx4 v19, s[32:35], s27 offen lds
  s_mov_b32 s80, 458752
  buffer_load_dwordx4 v[108:111], v20, s[36:39], s80 offen
  s_mov_b32 s80, 491520
  buffer_load_dwordx4 v[112:115], v20, s[36:39], s80 offen
  s_mov_b32 s80, 655360
  buffer_load_dwordx4 v[116:119], v20, s[36:39], s80 offen
  s_mov_b32 s80, 688128
  buffer_load_dwordx4 v[120:123], v20, s[36:39], s80 offen
  s_waitcnt vmcnt(10)
  s_barrier
  s_lshl_b32 s27, s62, 1
  s_mul_i32 s27, s27, s78
  s_add_u32 m0, s85, 139264
  s_nop 0
  buffer_load_dwordx4 v18, s[32:35], s27 offen lds
  s_add_u32 m0, s85, 143360
  s_nop 0
  buffer_load_dwordx4 v19, s[32:35], s27 offen lds
  s_mov_b32 s80, 851968
  buffer_load_dwordx4 v[124:127], v20, s[36:39], s80 offen
  s_mov_b32 s80, 884736
  buffer_load_dwordx4 v[128:131], v20, s[36:39], s80 offen
  s_mov_b32 s80, 1048576
  buffer_load_dwordx4 v[132:135], v20, s[36:39], s80 offen
  s_waitcnt vmcnt(9)
  s_barrier
  s_lshl_b32 s27, s63, 1
  s_mul_i32 s27, s27, s78
  s_add_u32 m0, s85, 147456
  s_nop 0
  buffer_load_dwordx4 v18, s[32:35], s27 offen lds
  s_add_u32 m0, s85, 151552
  s_nop 0
  buffer_load_dwordx4 v19, s[32:35], s27 offen lds
  s_mov_b32 s80, 1081344
  buffer_load_dwordx4 v[136:139], v20, s[36:39], s80 offen
  s_mov_b32 s80, 1245184
  buffer_load_dwordx4 v[140:143], v20, s[36:39], s80 offen
  s_mov_b32 s80, 1277952
  buffer_load_dwordx4 v[144:147], v20, s[36:39], s80 offen
  s_mov_b32 s80, 131072
  buffer_load_dwordx4 v[148:151], v20, s[36:39], s80 offen
  s_waitcnt vmcnt(9)
  s_barrier
  s_mov_b32 s80, 163840
  buffer_load_dwordx4 v[152:155], v20, s[36:39], s80 offen
  s_mov_b32 s80, 327680
  buffer_load_dwordx4 v[156:159], v20, s[36:39], s80 offen
  s_mov_b32 s80, 360448
  buffer_load_dwordx4 v[160:163], v20, s[36:39], s80 offen
  s_mov_b32 s80, 950272
  buffer_load_dwordx4 v[164:167], v20, s[36:39], s80 offen
  s_waitcnt vmcnt(8)
  s_barrier
  s_mov_b32 s80, 1114112
  buffer_load_dwordx4 v[168:171], v20, s[36:39], s80 offen
  s_mov_b32 s80, 1146880
  buffer_load_dwordx4 v[172:175], v20, s[36:39], s80 offen
  s_mov_b32 s80, 1310720
  buffer_load_dwordx4 v[176:179], v20, s[36:39], s80 offen
  s_barrier
  s_add_u32 m0, s85, 135168
  s_mov_b32 s80, 524288
  buffer_load_dwordx4 v20, s[36:39], s80 offen lds
  s_add_u32 m0, s85, 139264
  s_mov_b32 s80, 557056
  buffer_load_dwordx4 v20, s[36:39], s80 offen lds
  s_add_u32 m0, s85, 143360
  s_mov_b32 s80, 720896
  buffer_load_dwordx4 v20, s[36:39], s80 offen lds
  s_add_u32 m0, s85, 147456
  s_mov_b32 s80, 753664
  buffer_load_dwordx4 v20, s[36:39], s80 offen lds
  ds_write_b128 v24, v[32:35] offset:0
  ds_write_b128 v24, v[36:39] offset:4096
  ds_write_b128 v24, v[40:43] offset:8192
  s_add_u32 m0, s85, 151552
  s_mov_b32 s80, 917504
  buffer_load_dwordx4 v20, s[36:39], s80 offen lds
  ds_write_b128 v24, v[44:47] offset:12288
  ds_write_b128 v24, v[48:51] offset:16384
  ds_write_b128 v24, v[52:55] offset:20480
  s_mov_b32 s80, 1343488
  buffer_load_dwordx4 v[180:183], v20, s[36:39], s80 offen
  ds_write_b128 v24, v[56:59] offset:24576
  ds_write_b128 v24, v[60:63] offset:28672
  v_mov_b32 v22, 1
  ds_write_b32 v28, v22
  ds_write_b128 v24, v[64:67] offset:32768
  s_mov_b32 s80, 0
  buffer_load_dwordx4 v[184:187], v20, s[40:43], s80 offen
  ds_write_b128 v24, v[68:71] offset:36864
  ds_write_b128 v24, v[72:75] offset:40960
  ds_write_b128 v24, v[76:79] offset:45056
  s_mov_b32 s80, 32768
  buffer_load_dwordx4 v[188:191], v20, s[40:43], s80 offen
  ds_write_b128 v24, v[80:83] offset:49152
  ds_write_b128 v24, v[84:87] offset:53248
  ds_write_b128 v24, v[88:91] offset:57344
  s_mov_b32 s80, 65536
  buffer_load_dwordx4 v[192:195], v20, s[40:43], s80 offen
  ds_write_b128 v24, v[92:95] offset:61440
  ds_write_b128 v25, v[96:99] offset:0
  ds_write_b128 v25, v[100:103] offset:4096
  s_mov_b32 s80, 98304
  buffer_load_dwordx4 v[196:199], v20, s[40:43], s80 offen
  ds_write_b128 v25, v[104:107] offset:8192
  ds_write_b128 v25, v[108:111] offset:12288
  ds_write_b128 v25, v[112:115] offset:16384
  s_mov_b32 s80, 131072
  buffer_load_dwordx4 v[200:203], v20, s[40:43], s80 offen
  ds_write_b128 v25, v[116:119] offset:20480
  ds_write_b128 v25, v[120:123] offset:24576
  v_mov_b32 v22, 2
  ds_write_b32 v28, v22
  ds_write_b128 v25, v[124:127] offset:28672
  s_mov_b32 s80, 163840
  buffer_load_dwordx4 v[204:207], v20, s[40:43], s80 offen
  ds_write_b128 v25, v[128:131] offset:32768
  ds_write_b128 v25, v[132:135] offset:36864
  s_waitcnt vmcnt(22)
  ds_write_b128 v25, v[136:139] offset:40960
  s_mov_b32 s80, 196608
  buffer_load_dwordx4 v[208:211], v20, s[40:43], s80 offen
  s_waitcnt vmcnt(22)
  ds_write_b128 v25, v[140:143] offset:45056
  s_waitcnt vmcnt(21)
  ds_write_b128 v25, v[144:147] offset:49152
  s_waitcnt vmcnt(20)
  ds_write_b128 v25, v[148:151] offset:53248
  s_mov_b32 s80, 229376
  buffer_load_dwordx4 v[212:215], v20, s[40:43], s80 offen
  s_waitcnt vmcnt(20)
  ds_write_b128 v25, v[152:155] offset:57344
  s_waitcnt vmcnt(19)
  ds_write_b128 v25, v[156:159] offset:61440
  s_waitcnt vmcnt(18)
  ds_write_b128 v26, v[160:163] offset:0
  s_mov_b32 s80, 262144
  buffer_load_dwordx4 v[216:219], v20, s[40:43], s80 offen
  s_mov_b32 s80, 294912
  buffer_load_dwordx4 v[220:223], v20, s[40:43], s80 offen
  s_waitcnt vmcnt(11)
  v_mov_b32 v22, 3
  ds_write_b32 v28, v22
  s_mov_b32 s80, 327680
  buffer_load_dwordx4 v[224:227], v20, s[40:43], s80 offen
  s_mov_b32 s80, 360448
  buffer_load_dwordx4 v[228:231], v20, s[40:43], s80 offen
  s_mov_b32 s80, 393216
  buffer_load_dwordx4 v[232:235], v20, s[40:43], s80 offen
  s_mov_b32 s80, 425984
  buffer_load_dwordx4 v[236:239], v20, s[40:43], s80 offen
  s_mov_b32 s80, 458752
  buffer_load_dwordx4 v[240:243], v20, s[40:43], s80 offen
  s_mov_b32 s80, 491520
  buffer_load_dwordx4 v[244:247], v20, s[40:43], s80 offen
  s_waitcnt vmcnt(14)
  s_mov_b32 s84, 0
Ldw_8:
  ds_read_b32 v21, v29
  s_add_u32 s84, s84, 1
  s_cmp_gt_u32 s84, 2097152
  s_waitcnt lgkmcnt(0)
  s_cbranch_scc1 Ldwx_9
  v_cmp_gt_u32 vcc, 2, v21
  s_cbranch_vccnz Ldw_8
Ldwx_9:
  ds_write_b128 v24, v[164:167] offset:0
  ds_write_b128 v24, v[168:171] offset:4096
  ds_write_b128 v24, v[172:175] offset:8192
  ds_write_b128 v24, v[176:179] offset:12288
  ds_write_b128 v24, v[180:183] offset:16384
  ds_write_b128 v24, v[184:187] offset:20480
  ds_write_b128 v24, v[188:191] offset:24576
  v_mov_b32 v22, 4
  ds_write_b32 v28, v22
  s_waitcnt vmcnt(4)
  s_mov_b32 s84, 0
Ldw_10:
  ds_read_b32 v21, v29
  s_add_u32 s84, s84, 1
  s_cmp_gt_u32 s84, 2097152
  s_waitcnt lgkmcnt(0)
  s_cbranch_scc1 Ldwx_11
  v_cmp_gt_u32 vcc, 3, v21
  s_cbranch_vccnz Ldw_10
Ldwx_11:
  ds_write_b128 v24, v[192:195] offset:28672
  ds_write_b128 v24, v[196:199] offset:32768
  ds_write_b128 v24, v[200:203] offset:36864
  ds_write_b128 v24, v[204:207] offset:40960
  ds_write_b128 v24, v[208:211] offset:45056
  ds_write_b128 v24, v[212:215] offset:49152
  ds_write_b128 v24, v[216:219] offset:53248
  ds_write_b128 v24, v[220:223] offset:57344
  ds_write_b128 v24, v[224:227] offset:61440
  ds_write_b128 v25, v[228:231] offset:0
  v_mov_b32 v22, 5
  ds_write_b32 v28, v22
  s_waitcnt vmcnt(0)
  s_mov_b32 s84, 0
Ldw_12:
  ds_read_b32 v21, v29
  s_add_u32 s84, s84, 1
  s_cmp_gt_u32 s84, 2097152
  s_waitcnt lgkmcnt(0)
  s_cbranch_scc1 Ldwx_13
  v_cmp_gt_u32 vcc, 4, v21
  s_cbranch_vccnz Ldw_12
Ldwx_13:
  ds_write_b128 v25, v[232:235] offset:4096
  ds_write_b128 v25, v[236:239] offset:8192
  ds_write_b128 v25, v[240:243] offset:12288
  ds_write_b128 v25, v[244:247] offset:16384
  v_mov_b32 v22, 6
  ds_write_b32 v28, v22
  s_waitcnt lgkmcnt(0)
  s_endpgm
L_compute:
  v_lshlrev_b32 v8, 4, v3
  v_lshl_add_u32 v8, v2, 5, v8
  s_lshl_b32 s75, s75, 5
  v_add_u32 v8, s75, v8
  v_mov_b32 v9, 0x80000000
  v_cmp_gt_u32 vcc, 2, v2
  v_add_u32 v8, 8781824, v8
  s_nop 0
  v_cndmask_b32 v124, v9, v8, vcc
  v_cmp_gt_u32 vcc, 32, v1
  v_lshlrev_b32 v8, 2, v1
  s_nop 0
  v_cndmask_b32 v7, v9, v8, vcc
  s_lshl_b32 s77, s71, 6
  s_add_u32 s76, s76, s77
  v_add_u32 v8, s76, v2
  v_and_b32 v10, 1, v8
  v_lshlrev_b32 v8, 5, v8
  v_mul_u32_u24 v10, 16, v10
  v_sub_u32 v8, v8, v10
  v_add_u32 v125, 8781824, v8
  v_bfe_u32 v8, v1, 1, 3
  s_lshl_b32 s77, s71, 13
  v_lshl_add_u32 v9, v2, 7, s77
  s_xor_b32 s78, s71, 0
  s_lshl_b32 s78, s78, 1
  v_add_u32 v10, s78, v3
  v_xor_b32 v10, v10, v8
  v_lshl_add_u32 v76, v10, 4, v9
  v_add_u32 v80, 65536, v76
  s_xor_b32 s78, s71, 1
  s_lshl_b32 s78, s78, 1
  v_add_u32 v10, s78, v3
  v_xor_b32 v10, v10, v8
  v_lshl_add_u32 v77, v10, 4, v9
  v_add_u32 v81, 65536, v77
  s_xor_b32 s78, s71, 2
  s_lshl_b32 s78, s78, 1
  v_add_u32 v10, s78, v3
  v_xor_b32 v10, v10, v8
  v_lshl_add_u32 v78, v10, 4, v9
  v_add_u32 v82, 65536, v78
  s_xor_b32 s78, s71, 3
  s_lshl_b32 s78, s78, 1
  v_add_u32 v10, s78, v3
  v_xor_b32 v10, v10, v8
  v_lshl_add_u32 v79, v10, 4, v9
  v_add_u32 v83, 65536, v79
  v_lshrrev_b32 v8, 2, v5
  v_lshl_add_u32 v8, v3, 3, v8
  v_lshlrev_b32 v8, 7, v8
  v_and_b32 v9, 1, v4
  v_lshlrev_b32 v9, 1, v9
  v_bfe_u32 v10, v5, 1, 1
  v_add_u32 v9, v9, v10
  v_lshrrev_b32 v10, 3, v5
  v_lshlrev_b32 v10, 2, v10
  v_xor_b32 v9, v9, v10
  v_and_b32 v10, 1, v5
  v_lshlrev_b32 v10, 3, v10
  v_add_u32 v8, v8, v10
  s_xor_b32 s78, s67, 1
  s_and_b32 s78, s78, s71
  s_lshl_b32 s78, s78, 1
  s_lshl_b32 s77, s72, 2
  s_or_b32 s77, s77, s78
  v_xor_b32 v10, s77, v9
  v_lshl_add_u32 v10, v10, 4, v8
  s_lshl_b32 s77, s71, 11
  s_add_u32 s79, s77, 131072
  s_sub_u32 s80, 131072, s77
  v_add_u32 v84, s79, v10
  v_add_u32 v87, s80, v10
  s_add_u32 s79, s77, 139264
  s_sub_u32 s80, 139264, s77
  v_add_u32 v85, s79, v10
  v_add_u32 v88, s80, v10
  s_add_u32 s79, s77, 147456
  s_sub_u32 s80, 147456, s77
  v_add_u32 v86, s79, v10
  v_add_u32 v89, s80, v10
  v_lshrrev_b32 v8, 2, v5
  v_xor_b32 v8, v8, v4
  v_and_b32 v8, 1, v8
  v_cmp_eq_u32 vcc, 0, v8
  v_mov_b32 v9, 0x3f803f80
  s_nop 0
  v_cndmask_b32 v64, 0, v9, vcc
  v_cndmask_b32 v65, 0, v9, vcc
  v_cndmask_b32 v66, 0, v9, vcc
  v_cndmask_b32 v67, 0, v9, vcc
  s_mul_i32 s75, s64, 384
  s_add_u32 s75, s75, 155904
  v_lshl_add_u32 v94, v2, 2, s75
  s_xor_b32 s75, s64, 2
  s_mul_i32 s75, s75, 384
  s_add_u32 s75, s75, 155904
  s_xor_b32 s76, s67, 1
  s_lshl_b32 s76, s76, 4
  v_xor_b32 v8, s76, v2
  v_lshl_add_u32 v95, v8, 2, s75
  v_lshlrev_b32 v8, 2, v2
  v_add_u32 v8, 155712, v8
  ds_write_b32 v8, v126
  v_mov_b32 v98, 0x80000000
  v_mov_b32 v99, 0x80000000
  s_cmp_lt_u32 s64, 2
  s_cbranch_scc1 Lvwx_14
  s_cmp_eq_u32 s64, 2
  s_cselect_b32 s32, s16, s8
  s_cselect_b32 s33, s17, s9
  s_movk_i32 s78, 2048
  s_cselect_b32 s78, 5504, s78
  s_lshl_b32 s34, s78, 8
  s_mul_i32 s77, s2, s78
  s_sub_u32 s78, s78, 4
  v_lshlrev_b32 v12, 7, v1
  v_min_u32 v12, s78, v12
  v_add_u32 v98, s77, v12
  s_cmp_eq_u32 s64, 2
  s_cselect_b32 s78, 43, 16
  s_lshr_b32 s77, s2, 3
  s_mul_i32 s77, s77, s78
  v_add_u32 v12, s77, v1
  v_lshlrev_b32 v12, 10, v12
  v_add_u32 v12, 384, v12
  v_cmp_gt_u32 vcc, s78, v1
  s_nop 1
  v_cndmask_b32 v99, v99, v12, vcc
Lvwx_14:
  s_mov_b32 s56, s14
  s_mov_b32 s57, s15
  s_mov_b32 s58, 2752
  s_mov_b32 s59, 0x00020000
  s_mov_b32 s48, s22
  s_mov_b32 s49, s23
  s_mov_b32 s50, 256
  s_mov_b32 s51, 0x00020000
  s_mov_b32 s44, s24
  s_mov_b32 s45, s25
  s_mov_b32 s46, 268435456
  s_mov_b32 s47, 0x00020000
  s_lshl_b32 s77, s72, 6
  s_lshl_b32 s78, s67, 31
  s_xor_b32 s78, s78, 0x80000000
  s_or_b32 s77, s77, s78
  v_lshl_add_u32 v8, v2, 1, s77
  v_mov_b32 v96, v8
  s_lshl_b32 s77, s68, 2
  s_or_b32 s77, s77, s64
  s_cmp_lg_u32 s77, 3
  s_cbranch_scc1 Lt2_15
  s_mov_b32 s52, s6
  s_mov_b32 s53, s7
  s_mov_b32 s54, 1572864
  s_mov_b32 s55, 0x00020000
  s_lshr_b32 s77, s2, 3
  s_lshl_b32 s77, s77, 4
  v_add_u32 v12, s77, v5
  v_mul_u32_u24 v12, 3072, v12
  v_min_u32 v13, 2, v4
  v_lshl_add_u32 v12, v13, 10, v12
  v_add_u32 v12, 384, v12
  buffer_load_dword v127, v12, s[52:55], 0 offen
Lt2_15:
  s_cmp_eq_u32 s67, 0
  s_cbranch_scc0 L_typeB
  v_and_b32 v8, 1, v4
  v_lshlrev_b32 v8, 2, v8
  v_sub_u32 v8, v5, v8
  v_mov_b32 v9, 0x3f80
  v_mov_b32 v10, 0x3f800000
  v_cmp_eq_u32 vcc, 0, v8
  s_nop 1
  v_cndmask_b32 v11, 0, v9, vcc
  v_cmp_eq_u32 vcc, 1, v8
  s_nop 1
  v_cndmask_b32 v108, v11, v10, vcc
  v_cmp_eq_u32 vcc, 2, v8
  s_nop 1
  v_cndmask_b32 v11, 0, v9, vcc
  v_cmp_eq_u32 vcc, 3, v8
  s_nop 1
  v_cndmask_b32 v109, v11, v10, vcc
  v_cmp_eq_u32 vcc, 8, v8
  s_nop 1
  v_cndmask_b32 v11, 0, v9, vcc
  v_cmp_eq_u32 vcc, 9, v8
  s_nop 1
  v_cndmask_b32 v110, v11, v10, vcc
  v_cmp_eq_u32 vcc, 10, v8
  s_nop 1
  v_cndmask_b32 v11, 0, v9, vcc
  v_cmp_eq_u32 vcc, 11, v8
  s_nop 1
  v_cndmask_b32 v111, v11, v10, vcc
  s_lshl_b32 s3, s66, 1
  s_add_u32 s3, s3, s72
  s_lshl_b32 s3, s3, 1
  s_add_u32 s3, s3, s71
  s_mul_i32 s26, s3, 10240
  s_add_u32 s26, s26, 8388608
  s_lshl_b32 s27, s3, 11
  s_add_u32 s27, s27, 9175040
  s_lshl_b32 s3, s65, 7
  s_add_u32 s3, s3, s27
  s_mul_i32 s85, s65, 640
  s_add_u32 s85, s85, s26
  v_cmp_gt_u32 s[60:61], 16, v2
  v_lshl_add_u32 v12, v3, 4, v2
  v_lshlrev_b32 v12, 4, v12
  v_lshlrev_b32 v13, 6, v3
  v_add_u32 v13, 512, v13
  v_cndmask_b32 v14, v13, v12, s[60:61]
  v_lshl_add_u32 v13, v5, 4, v13
  v_cndmask_b32 v15, v13, v12, s[60:61]
  v_mov_b32 v12, 0x80000000
  v_cmp_gt_u32 vcc, 20, v2
  s_nop 1
  v_cndmask_b32 v15, v12, v15, vcc
  v_mov_b32 v9, 0x3f317218
  v_cndmask_b32 v0, 1.0, v9, s[60:61]
  v_mov_b32 v10, 0x35c1a2a0
  v_mov_b32 v11, v9
  s_waitcnt vmcnt(1)
  buffer_load_dword v93, v126, s[48:51], 0 offen sc1
  v_lshlrev_b32 v136, 16, v128
  v_and_b32 v137, 0xffff0000, v128
  v_lshlrev_b32 v138, 16, v129
  v_and_b32 v139, 0xffff0000, v129
  v_lshlrev_b32 v140, 16, v130
  v_and_b32 v141, 0xffff0000, v130
  v_lshlrev_b32 v142, 16, v131
  v_and_b32 v143, 0xffff0000, v131
  v_lshlrev_b32 v144, 16, v132
  v_and_b32 v145, 0xffff0000, v132
  v_lshlrev_b32 v146, 16, v133
  v_and_b32 v147, 0xffff0000, v133
  v_lshlrev_b32 v148, 16, v134
  v_and_b32 v149, 0xffff0000, v134
  v_lshlrev_b32 v150, 16, v135
  v_and_b32 v151, 0xffff0000, v135
  v_add_f32 v128, v136, v137
  v_add_f32 v129, v138, v139
  v_add_f32 v130, v140, v141
  v_add_f32 v131, v142, v143
  v_add_f32 v132, v144, v145
  v_add_f32 v133, v146, v147
  v_add_f32 v134, v148, v149
  v_add_f32 v135, v150, v151
  v_add_f32 v128, v128, v132
  v_add_f32 v129, v129, v133
  v_add_f32 v130, v130, v134
  v_add_f32 v131, v131, v135
  v_add_f32 v128, v128, v130
  v_add_f32 v129, v129, v131
  v_add_f32 v128, v128, v129
  s_nop 1
  v_add_f32_dpp v128, v128, v128 quad_perm:[1,0,3,2] row_mask:0xf bank_mask:0xf
  s_nop 1
  v_add_f32_dpp v128, v128, v128 quad_perm:[2,3,0,1] row_mask:0xf bank_mask:0xf
  s_nop 1
  v_add_f32_dpp v128, v128, v128 row_half_mirror row_mask:0xf bank_mask:0xf
  s_nop 1
  v_add_f32_dpp v128, v128, v128 row_mirror row_mask:0xf bank_mask:0xf
  v_mov_b32 v129, v128
  s_nop 1
  v_permlane16_swap_b32 v128, v129
  v_add_f32 v128, v128, v129
  v_mul_f32 v90, 0x3b000000, v128
  v_sub_f32 v136, v136, v90
  v_sub_f32 v137, v137, v90
  v_sub_f32 v138, v138, v90
  v_sub_f32 v139, v139, v90
  v_sub_f32 v140, v140, v90
  v_sub_f32 v141, v141, v90
  v_sub_f32 v142, v142, v90
  v_sub_f32 v143, v143, v90
  v_sub_f32 v144, v144, v90
  v_sub_f32 v145, v145, v90
  v_sub_f32 v146, v146, v90
  v_sub_f32 v147, v147, v90
  v_sub_f32 v148, v148, v90
  v_sub_f32 v149, v149, v90
  v_sub_f32 v150, v150, v90
  v_sub_f32 v151, v151, v90
  v_mul_f32 v128, v136, v136
  v_mul_f32 v129, v137, v137
  v_mul_f32 v130, v138, v138
  v_mul_f32 v131, v139, v139
  v_fmac_f32 v128, v140, v140
  v_fmac_f32 v129, v141, v141
  v_fmac_f32 v130, v142, v142
  v_fmac_f32 v131, v143, v143
  v_fmac_f32 v128, v144, v144
  v_fmac_f32 v129, v145, v145
  v_fmac_f32 v130, v146, v146
  v_fmac_f32 v131, v147, v147
  v_fmac_f32 v128, v148, v148
  v_fmac_f32 v129, v149, v149
  v_fmac_f32 v130, v150, v150
  v_fmac_f32 v131, v151, v151
  v_add_f32 v128, v128, v129
  v_add_f32 v130, v130, v131
  v_add_f32 v128, v128, v130
  s_nop 1
  v_add_f32_dpp v128, v128, v128 quad_perm:[1,0,3,2] row_mask:0xf bank_mask:0xf
  s_nop 1
  v_add_f32_dpp v128, v128, v128 quad_perm:[2,3,0,1] row_mask:0xf bank_mask:0xf
  s_nop 1
  v_add_f32_dpp v128, v128, v128 row_half_mirror row_mask:0xf bank_mask:0xf
  s_nop 1
  v_add_f32_dpp v128, v128, v128 row_mirror row_mask:0xf bank_mask:0xf
  v_mov_b32 v129, v128
  s_nop 1
  v_permlane16_swap_b32 v128, v129
  v_add_f32 v128, v128, v129
  v_mov_b32 v129, 0x3727c5ac
  v_fmac_f32 v129, 0x3b000000, v128
  v_rsq_f32 v91, v129
  s_nop 0
  v_mul_f32 v92, v129, v91
  s_waitcnt lgkmcnt(0)
  s_barrier
  ds_read_b64_tr_b16 v[48:49], v84 offset:0
  ds_read_b64_tr_b16 v[50:51], v84 offset:512
  ds_read_b128 v[16:19], v76 offset:0
  ds_read_b64_tr_b16 v[52:53], v84 offset:4096
  ds_read_b64_tr_b16 v[54:55], v84 offset:4608
  ds_read_b128 v[20:23], v76 offset:4096
  s_waitcnt lgkmcnt(0)
  v_mfma_f32_32x32x16_bf16 v[160:175], v[16:19], v[48:51], 0
  ds_read_b64_tr_b16 v[56:57], v87 offset:2048
  ds_read_b64_tr_b16 v[58:59], v87 offset:2560
  ds_read_b128 v[24:27], v77 offset:0
  v_mfma_f32_32x32x16_bf16 v[176:191], v[20:23], v[48:51], 0
  ds_read_b64_tr_b16 v[60:61], v87 offset:6144
  ds_read_b64_tr_b16 v[62:63], v87 offset:6656
  ds_read_b128 v[28:31], v77 offset:4096
  v_mfma_f32_32x32x16_bf16 v[208:223], v[20:23], v[52:55], 0
  v_mfma_f32_16x16x32_bf16 v[68:71], v[64:67], v[48:51], 0
  v_mfma_f32_16x16x32_bf16 v[72:75], v[64:67], v[52:55], 0
  v_mfma_f32_32x32x16_bf16 v[192:207], v[16:19], v[52:55], 0
  s_waitcnt lgkmcnt(0)
  v_mfma_f32_32x32x16_bf16 v[160:175], v[24:27], v[56:59], v[160:175]
  s_barrier
  ds_read_b64_tr_b16 v[48:49], v85 offset:0
  ds_read_b64_tr_b16 v[50:51], v85 offset:512
  ds_read_b128 v[16:19], v78 offset:0
  v_mfma_f32_32x32x16_bf16 v[176:191], v[28:31], v[56:59], v[176:191]
  ds_read_b64_tr_b16 v[52:53], v85 offset:4096
  ds_read_b64_tr_b16 v[54:55], v85 offset:4608
  ds_read_b128 v[20:23], v78 offset:4096
  v_mfma_f32_32x32x16_bf16 v[208:223], v[28:31], v[60:63], v[208:223]
  v_mfma_f32_32x32x16_bf16 v[192:207], v[24:27], v[60:63], v[192:207]
  s_waitcnt lgkmcnt(0)
  v_mfma_f32_32x32x16_bf16 v[160:175], v[16:19], v[48:51], v[160:175]
  ds_read_b64_tr_b16 v[56:57], v88 offset:2048
  ds_read_b64_tr_b16 v[58:59], v88 offset:2560
  ds_read_b128 v[24:27], v79 offset:0
  s_waitcnt vmcnt(0)
  v_readfirstlane_b32 s73, v93
  s_nop 0
  s_cmp_eq_u32 s73, 0
  s_cbranch_scc1 Lnonce_16
Lnonceok_17:
  buffer_store_dwordx4 v[90:93], v124, s[44:47], 0 offen sc1
  v_mfma_f32_32x32x16_bf16 v[176:191], v[20:23], v[48:51], v[176:191]
  ds_read_b64_tr_b16 v[60:61], v88 offset:6144
  ds_read_b64_tr_b16 v[62:63], v88 offset:6656
  ds_read_b128 v[28:31], v79 offset:4096
  v_mov_b32 v8, 155648
  ds_write_b32 v8, v93
  v_mfma_f32_32x32x16_bf16 v[208:223], v[20:23], v[52:55], v[208:223]
  v_mfma_f32_16x16x32_bf16 v[68:71], v[64:67], v[48:51], v[68:71]
  v_mfma_f32_16x16x32_bf16 v[72:75], v[64:67], v[52:55], v[72:75]
  v_mfma_f32_32x32x16_bf16 v[192:207], v[16:19], v[52:55], v[192:207]
  s_waitcnt lgkmcnt(1)
  v_mfma_f32_32x32x16_bf16 v[160:175], v[24:27], v[56:59], v[160:175]
  s_waitcnt lgkmcnt(0)
  s_barrier
  ds_read_b64_tr_b16 v[48:49], v86 offset:0
  ds_read_b64_tr_b16 v[50:51], v86 offset:512
  ds_read_b128 v[16:19], v76 offset:16384
  v_mfma_f32_32x32x16_bf16 v[176:191], v[28:31], v[56:59], v[176:191]
  ds_read_b64_tr_b16 v[52:53], v86 offset:4096
  ds_read_b64_tr_b16 v[54:55], v86 offset:4608
  ds_read_b128 v[20:23], v76 offset:20480
  v_mfma_f32_32x32x16_bf16 v[208:223], v[28:31], v[60:63], v[208:223]
  v_mfma_f32_32x32x16_bf16 v[192:207], v[24:27], v[60:63], v[192:207]
  s_waitcnt lgkmcnt(0)
  v_mfma_f32_32x32x16_bf16 v[160:175], v[16:19], v[48:51], v[160:175]
  ds_read_b64_tr_b16 v[56:57], v89 offset:2048
  ds_read_b64_tr_b16 v[58:59], v89 offset:2560
  ds_read_b128 v[24:27], v77 offset:16384
  buffer_load_dword v127, v98, s[32:35], 0 offen
  v_mfma_f32_32x32x16_bf16 v[176:191], v[20:23], v[48:51], v[176:191]
  ds_read_b64_tr_b16 v[60:61], v89 offset:6144
  ds_read_b64_tr_b16 v[62:63], v89 offset:6656
  ds_read_b128 v[28:31], v77 offset:20480
  v_mfma_f32_32x32x16_bf16 v[208:223], v[20:23], v[52:55], v[208:223]
  v_mfma_f32_16x16x32_bf16 v[68:71], v[64:67], v[48:51], v[68:71]
  v_mfma_f32_16x16x32_bf16 v[72:75], v[64:67], v[52:55], v[72:75]
  v_mfma_f32_32x32x16_bf16 v[192:207], v[16:19], v[52:55], v[192:207]
  s_waitcnt lgkmcnt(0)
  v_mfma_f32_32x32x16_bf16 v[160:175], v[24:27], v[56:59], v[160:175]
  s_barrier
  ds_read_b64_tr_b16 v[48:49], v84 offset:0
  ds_read_b64_tr_b16 v[50:51], v84 offset:512
  ds_read_b128 v[16:19], v78 offset:16384
  v_mfma_f32_32x32x16_bf16 v[176:191], v[28:31], v[56:59], v[176:191]
  ds_read_b64_tr_b16 v[52:53], v84 offset:4096
  ds_read_b64_tr_b16 v[54:55], v84 offset:4608
  ds_read_b128 v[20:23], v78 offset:20480
  v_mfma_f32_32x32x16_bf16 v[208:223], v[28:31], v[60:63], v[208:223]
  v_mfma_f32_32x32x16_bf16 v[192:207], v[24:27], v[60:63], v[192:207]
  s_waitcnt lgkmcnt(0)
  v_mfma_f32_32x32x16_bf16 v[160:175], v[16:19], v[48:51], v[160:175]
  ds_read_b64_tr_b16 v[56:57], v87 offset:2048
  ds_read_b64_tr_b16 v[58:59], v87 offset:2560
  ds_read_b128 v[24:27], v79 offset:16384
  v_mfma_f32_32x32x16_bf16 v[176:191], v[20:23], v[48:51], v[176:191]
  ds_read_b64_tr_b16 v[60:61], v87 offset:6144
  ds_read_b64_tr_b16 v[62:63], v87 offset:6656
  ds_read_b128 v[28:31], v79 offset:20480
  v_mfma_f32_32x32x16_bf16 v[208:223], v[20:23], v[52:55], v[208:223]
  v_mfma_f32_16x16x32_bf16 v[68:71], v[64:67], v[48:51], v[68:71]
  v_mfma_f32_16x16x32_bf16 v[72:75], v[64:67], v[52:55], v[72:75]
  v_mfma_f32_32x32x16_bf16 v[192:207], v[16:19], v[52:55], v[192:207]
  s_waitcnt lgkmcnt(0)
  v_mfma_f32_32x32x16_bf16 v[160:175], v[24:27], v[56:59], v[160:175]
  s_barrier
  ds_read_b64_tr_b16 v[48:49], v85 offset:0
  ds_read_b64_tr_b16 v[50:51], v85 offset:512
  ds_read_b128 v[16:19], v76 offset:32768
  v_mfma_f32_32x32x16_bf16 v[176:191], v[28:31], v[56:59], v[176:191]
  ds_read_b64_tr_b16 v[52:53], v85 offset:4096
  ds_read_b64_tr_b16 v[54:55], v85 offset:4608
  ds_read_b128 v[20:23], v76 offset:36864
  v_mfma_f32_32x32x16_bf16 v[208:223], v[28:31], v[60:63], v[208:223]
  v_mfma_f32_32x32x16_bf16 v[192:207], v[24:27], v[60:63], v[192:207]
  s_waitcnt lgkmcnt(0)
  v_mfma_f32_32x32x16_bf16 v[160:175], v[16:19], v[48:51], v[160:175]
  ds_read_b64_tr_b16 v[56:57], v88 offset:2048
  ds_read_b64_tr_b16 v[58:59], v88 offset:2560
  ds_read_b128 v[24:27], v77 offset:32768
  v_mfma_f32_32x32x16_bf16 v[176:191], v[20:23], v[48:51], v[176:191]
  ds_read_b64_tr_b16 v[60:61], v88 offset:6144
  ds_read_b64_tr_b16 v[62:63], v88 offset:6656
  ds_read_b128 v[28:31], v77 offset:36864
  v_mfma_f32_32x32x16_bf16 v[208:223], v[20:23], v[52:55], v[208:223]
  v_mfma_f32_16x16x32_bf16 v[68:71], v[64:67], v[48:51], v[68:71]
  v_mfma_f32_16x16x32_bf16 v[72:75], v[64:67], v[52:55], v[72:75]
  v_mfma_f32_32x32x16_bf16 v[192:207], v[16:19], v[52:55], v[192:207]
  s_waitcnt lgkmcnt(0)
  v_mfma_f32_32x32x16_bf16 v[160:175], v[24:27], v[56:59], v[160:175]
  s_barrier
  ds_read_b64_tr_b16 v[48:49], v86 offset:0
  ds_read_b64_tr_b16 v[50:51], v86 offset:512
  ds_read_b128 v[16:19], v78 offset:32768
  v_mfma_f32_32x32x16_bf16 v[176:191], v[28:31], v[56:59], v[176:191]
  ds_read_b64_tr_b16 v[52:53], v86 offset:4096
  ds_read_b64_tr_b16 v[54:55], v86 offset:4608
  ds_read_b128 v[20:23], v78 offset:36864
  v_mfma_f32_32x32x16_bf16 v[208:223], v[28:31], v[60:63], v[208:223]
  v_mfma_f32_32x32x16_bf16 v[192:207], v[24:27], v[60:63], v[192:207]
  s_waitcnt lgkmcnt(0)
  v_mfma_f32_32x32x16_bf16 v[160:175], v[16:19], v[48:51], v[160:175]
  ds_read_b64_tr_b16 v[56:57], v89 offset:2048
  ds_read_b64_tr_b16 v[58:59], v89 offset:2560
  ds_read_b128 v[24:27], v79 offset:32768
  v_mfma_f32_32x32x16_bf16 v[176:191], v[20:23], v[48:51], v[176:191]
  ds_read_b64_tr_b16 v[60:61], v89 offset:6144
  ds_read_b64_tr_b16 v[62:63], v89 offset:6656
  ds_read_b128 v[28:31], v79 offset:36864
  v_mfma_f32_32x32x16_bf16 v[208:223], v[20:23], v[52:55], v[208:223]
  v_mfma_f32_16x16x32_bf16 v[68:71], v[64:67], v[48:51], v[68:71]
  v_mfma_f32_16x16x32_bf16 v[72:75], v[64:67], v[52:55], v[72:75]
  v_mfma_f32_32x32x16_bf16 v[192:207], v[16:19], v[52:55], v[192:207]
  s_waitcnt lgkmcnt(0)
  v_mfma_f32_32x32x16_bf16 v[160:175], v[24:27], v[56:59], v[160:175]
  s_barrier
  ds_read_b64_tr_b16 v[48:49], v84 offset:0
  ds_read_b64_tr_b16 v[50:51], v84 offset:512
  ds_read_b128 v[16:19], v76 offset:49152
  v_mfma_f32_32x32x16_bf16 v[176:191], v[28:31], v[56:59], v[176:191]
  ds_read_b64_tr_b16 v[52:53], v84 offset:4096
  ds_read_b64_tr_b16 v[54:55], v84 offset:4608
  ds_read_b128 v[20:23], v76 offset:53248
  v_mfma_f32_32x32x16_bf16 v[208:223], v[28:31], v[60:63], v[208:223]
  v_mfma_f32_32x32x16_bf16 v[192:207], v[24:27], v[60:63], v[192:207]
  s_waitcnt lgkmcnt(0)
  v_mfma_f32_32x32x16_bf16 v[160:175], v[16:19], v[48:51], v[160:175]
  ds_read_b64_tr_b16 v[56:57], v87 offset:2048
  ds_read_b64_tr_b16 v[58:59], v87 offset:2560
  ds_read_b128 v[24:27], v77 offset:49152
  v_mfma_f32_32x32x16_bf16 v[176:191], v[20:23], v[48:51], v[176:191]
  ds_read_b64_tr_b16 v[60:61], v87 offset:6144
  ds_read_b64_tr_b16 v[62:63], v87 offset:6656
  ds_read_b128 v[28:31], v77 offset:53248
  v_mfma_f32_32x32x16_bf16 v[208:223], v[20:23], v[52:55], v[208:223]
  v_mfma_f32_16x16x32_bf16 v[68:71], v[64:67], v[48:51], v[68:71]
  v_mfma_f32_16x16x32_bf16 v[72:75], v[64:67], v[52:55], v[72:75]
  v_mfma_f32_32x32x16_bf16 v[192:207], v[16:19], v[52:55], v[192:207]
  s_waitcnt lgkmcnt(0)
  v_mfma_f32_32x32x16_bf16 v[160:175], v[24:27], v[56:59], v[160:175]
  s_barrier
  ds_read_b64_tr_b16 v[48:49], v85 offset:0
  ds_read_b64_tr_b16 v[50:51], v85 offset:512
  ds_read_b128 v[16:19], v78 offset:49152
  v_mfma_f32_32x32x16_bf16 v[176:191], v[28:31], v[56:59], v[176:191]
  ds_read_b64_tr_b16 v[52:53], v85 offset:4096
  ds_read_b64_tr_b16 v[54:55], v85 offset:4608
  ds_read_b128 v[20:23], v78 offset:53248
  v_mfma_f32_32x32x16_bf16 v[208:223], v[28:31], v[60:63], v[208:223]
  v_mfma_f32_32x32x16_bf16 v[192:207], v[24:27], v[60:63], v[192:207]
  s_waitcnt lgkmcnt(0)
  v_mfma_f32_32x32x16_bf16 v[160:175], v[16:19], v[48:51], v[160:175]
  ds_read_b64_tr_b16 v[56:57], v88 offset:2048
  ds_read_b64_tr_b16 v[58:59], v88 offset:2560
  ds_read_b128 v[24:27], v79 offset:49152
  buffer_load_dword v127, v99, s[32:35], 0 offen
  v_mfma_f32_32x32x16_bf16 v[176:191], v[20:23], v[48:51], v[176:191]
  ds_read_b64_tr_b16 v[60:61], v88 offset:6144
  ds_read_b64_tr_b16 v[62:63], v88 offset:6656
  ds_read_b128 v[28:31], v79 offset:53248
  v_mfma_f32_32x32x16_bf16 v[208:223], v[20:23], v[52:55], v[208:223]
  v_mfma_f32_16x16x32_bf16 v[68:71], v[64:67], v[48:51], v[68:71]
  v_mfma_f32_16x16x32_bf16 v[72:75], v[64:67], v[52:55], v[72:75]
  v_mfma_f32_32x32x16_bf16 v[192:207], v[16:19], v[52:55], v[192:207]
  s_waitcnt lgkmcnt(0)
  v_mfma_f32_32x32x16_bf16 v[160:175], v[24:27], v[56:59], v[160:175]
  s_barrier
  ds_read_b64_tr_b16 v[48:49], v86 offset:0
  ds_read_b64_tr_b16 v[50:51], v86 offset:512
  ds_read_b128 v[16:19], v80 offset:0
  v_mfma_f32_32x32x16_bf16 v[176:191], v[28:31], v[56:59], v[176:191]
  ds_read_b64_tr_b16 v[52:53], v86 offset:4096
  ds_read_b64_tr_b16 v[54:55], v86 offset:4608
  ds_read_b128 v[20:23], v80 offset:4096
  v_mfma_f32_32x32x16_bf16 v[208:223], v[28:31], v[60:63], v[208:223]
  v_mfma_f32_32x32x16_bf16 v[192:207], v[24:27], v[60:63], v[192:207]
  s_waitcnt lgkmcnt(0)
  v_mfma_f32_32x32x16_bf16 v[160:175], v[16:19], v[48:51], v[160:175]
  ds_read_b64_tr_b16 v[56:57], v89 offset:2048
  ds_read_b64_tr_b16 v[58:59], v89 offset:2560
  ds_read_b128 v[24:27], v81 offset:0
  v_mfma_f32_32x32x16_bf16 v[176:191], v[20:23], v[48:51], v[176:191]
  ds_read_b64_tr_b16 v[60:61], v89 offset:6144
  ds_read_b64_tr_b16 v[62:63], v89 offset:6656
  ds_read_b128 v[28:31], v81 offset:4096
  v_mfma_f32_32x32x16_bf16 v[208:223], v[20:23], v[52:55], v[208:223]
  v_mfma_f32_16x16x32_bf16 v[68:71], v[64:67], v[48:51], v[68:71]
  v_mfma_f32_16x16x32_bf16 v[72:75], v[64:67], v[52:55], v[72:75]
  v_mfma_f32_32x32x16_bf16 v[192:207], v[16:19], v[52:55], v[192:207]
  s_waitcnt lgkmcnt(0)
  v_mfma_f32_32x32x16_bf16 v[160:175], v[24:27], v[56:59], v[160:175]
  s_barrier
  ds_read_b64_tr_b16 v[48:49], v84 offset:0
  ds_read_b64_tr_b16 v[50:51], v84 offset:512
  ds_read_b128 v[16:19], v82 offset:0
  v_mfma_f32_32x32x16_bf16 v[176:191], v[28:31], v[56:59], v[176:191]
  ds_read_b64_tr_b16 v[52:53], v84 offset:4096
  ds_read_b64_tr_b16 v[54:55], v84 offset:4608
  ds_read_b128 v[20:23], v82 offset:4096
  v_mfma_f32_32x32x16_bf16 v[208:223], v[28:31], v[60:63], v[208:223]
  v_mfma_f32_32x32x16_bf16 v[192:207], v[24:27], v[60:63], v[192:207]
  s_waitcnt lgkmcnt(0)
  v_mfma_f32_32x32x16_bf16 v[160:175], v[16:19], v[48:51], v[160:175]
  ds_read_b64_tr_b16 v[56:57], v87 offset:2048
  ds_read_b64_tr_b16 v[58:59], v87 offset:2560
  ds_read_b128 v[24:27], v83 offset:0
  v_mfma_f32_32x32x16_bf16 v[176:191], v[20:23], v[48:51], v[176:191]
  ds_read_b64_tr_b16 v[60:61], v87 offset:6144
  ds_read_b64_tr_b16 v[62:63], v87 offset:6656
  ds_read_b128 v[28:31], v83 offset:4096
  v_mfma_f32_32x32x16_bf16 v[208:223], v[20:23], v[52:55], v[208:223]
  v_mfma_f32_16x16x32_bf16 v[68:71], v[64:67], v[48:51], v[68:71]
  v_mfma_f32_16x16x32_bf16 v[72:75], v[64:67], v[52:55], v[72:75]
  v_mfma_f32_32x32x16_bf16 v[192:207], v[16:19], v[52:55], v[192:207]
  s_waitcnt lgkmcnt(0)
  v_mfma_f32_32x32x16_bf16 v[160:175], v[24:27], v[56:59], v[160:175]
  s_barrier
  ds_read_b64_tr_b16 v[48:49], v85 offset:0
  ds_read_b64_tr_b16 v[50:51], v85 offset:512
  ds_read_b128 v[16:19], v80 offset:16384
  v_mfma_f32_32x32x16_bf16 v[176:191], v[28:31], v[56:59], v[176:191]
  ds_read_b64_tr_b16 v[52:53], v85 offset:4096
  ds_read_b64_tr_b16 v[54:55], v85 offset:4608
  ds_read_b128 v[20:23], v80 offset:20480
  v_mfma_f32_32x32x16_bf16 v[208:223], v[28:31], v[60:63], v[208:223]
  v_mfma_f32_32x32x16_bf16 v[192:207], v[24:27], v[60:63], v[192:207]
  s_waitcnt lgkmcnt(0)
  v_mfma_f32_32x32x16_bf16 v[160:175], v[16:19], v[48:51], v[160:175]
  ds_read_b64_tr_b16 v[56:57], v88 offset:2048
  ds_read_b64_tr_b16 v[58:59], v88 offset:2560
  ds_read_b128 v[24:27], v81 offset:16384
  buffer_load_dwordx4 v[100:103], v125, s[44:47], 0 offen offset:0 sc1
  buffer_load_dwordx4 v[104:107], v125, s[44:47], 0 offen offset:1024 sc1
  v_mfma_f32_32x32x16_bf16 v[176:191], v[20:23], v[48:51], v[176:191]
  ds_read_b64_tr_b16 v[60:61], v88 offset:6144
  ds_read_b64_tr_b16 v[62:63], v88 offset:6656
  ds_read_b128 v[28:31], v81 offset:20480
  v_mfma_f32_32x32x16_bf16 v[208:223], v[20:23], v[52:55], v[208:223]
  v_mfma_f32_16x16x32_bf16 v[68:71], v[64:67], v[48:51], v[68:71]
  v_mfma_f32_16x16x32_bf16 v[72:75], v[64:67], v[52:55], v[72:75]
  v_mfma_f32_32x32x16_bf16 v[192:207], v[16:19], v[52:55], v[192:207]
  s_waitcnt lgkmcnt(0)
  v_mfma_f32_32x32x16_bf16 v[160:175], v[24:27], v[56:59], v[160:175]
  s_barrier
  ds_read_b64_tr_b16 v[48:49], v86 offset:0
  ds_read_b64_tr_b16 v[50:51], v86 offset:512
  ds_read_b128 v[16:19], v82 offset:16384
  v_mfma_f32_32x32x16_bf16 v[176:191], v[28:31], v[56:59], v[176:191]
  ds_read_b64_tr_b16 v[52:53], v86 offset:4096
  ds_read_b64_tr_b16 v[54:55], v86 offset:4608
  ds_read_b128 v[20:23], v82 offset:20480
  v_mfma_f32_32x32x16_bf16 v[208:223], v[28:31], v[60:63], v[208:223]
  v_mfma_f32_32x32x16_bf16 v[192:207], v[24:27], v[60:63], v[192:207]
  s_waitcnt lgkmcnt(0)
  v_mfma_f32_32x32x16_bf16 v[160:175], v[16:19], v[48:51], v[160:175]
  ds_read_b64_tr_b16 v[56:57], v89 offset:2048
  ds_read_b64_tr_b16 v[58:59], v89 offset:2560
  ds_read_b128 v[24:27], v83 offset:16384
  v_mfma_f32_32x32x16_bf16 v[176:191], v[20:23], v[48:51], v[176:191]
  ds_read_b64_tr_b16 v[60:61], v89 offset:6144
  ds_read_b64_tr_b16 v[62:63], v89 offset:6656
  ds_read_b128 v[28:31], v83 offset:20480
  v_mfma_f32_32x32x16_bf16 v[208:223], v[20:23], v[52:55], v[208:223]
  v_mfma_f32_16x16x32_bf16 v[68:71], v[64:67], v[48:51], v[68:71]
  v_mfma_f32_16x16x32_bf16 v[72:75], v[64:67], v[52:55], v[72:75]
  v_mfma_f32_32x32x16_bf16 v[192:207], v[16:19], v[52:55], v[192:207]
  s_waitcnt lgkmcnt(0)
  v_mfma_f32_32x32x16_bf16 v[160:175], v[24:27], v[56:59], v[160:175]
  s_barrier
  ds_read_b64_tr_b16 v[48:49], v84 offset:0
  ds_read_b64_tr_b16 v[50:51], v84 offset:512
  ds_read_b128 v[16:19], v80 offset:32768
  v_mfma_f32_32x32x16_bf16 v[176:191], v[28:31], v[56:59], v[176:191]
  ds_read_b64_tr_b16 v[52:53], v84 offset:4096
  ds_read_b64_tr_b16 v[54:55], v84 offset:4608
  ds_read_b128 v[20:23], v80 offset:36864
  v_mfma_f32_32x32x16_bf16 v[208:223], v[28:31], v[60:63], v[208:223]
  v_mfma_f32_32x32x16_bf16 v[192:207], v[24:27], v[60:63], v[192:207]
  s_waitcnt lgkmcnt(0)
  v_mfma_f32_32x32x16_bf16 v[160:175], v[16:19], v[48:51], v[160:175]
  ds_read_b64_tr_b16 v[56:57], v87 offset:2048
  ds_read_b64_tr_b16 v[58:59], v87 offset:2560
  ds_read_b128 v[24:27], v81 offset:32768
  v_mfma_f32_32x32x16_bf16 v[176:191], v[20:23], v[48:51], v[176:191]
  ds_read_b64_tr_b16 v[60:61], v87 offset:6144
  ds_read_b64_tr_b16 v[62:63], v87 offset:6656
  ds_read_b128 v[28:31], v81 offset:36864
  v_mfma_f32_32x32x16_bf16 v[208:223], v[20:23], v[52:55], v[208:223]
  v_mfma_f32_16x16x32_bf16 v[68:71], v[64:67], v[48:51], v[68:71]
  v_mfma_f32_16x16x32_bf16 v[72:75], v[64:67], v[52:55], v[72:75]
  v_mfma_f32_32x32x16_bf16 v[192:207], v[16:19], v[52:55], v[192:207]
  s_waitcnt lgkmcnt(0)
  v_mfma_f32_32x32x16_bf16 v[160:175], v[24:27], v[56:59], v[160:175]
  s_barrier
  ds_read_b64_tr_b16 v[48:49], v85 offset:0
  ds_read_b64_tr_b16 v[50:51], v85 offset:512
  ds_read_b128 v[16:19], v82 offset:32768
  v_mfma_f32_32x32x16_bf16 v[176:191], v[28:31], v[56:59], v[176:191]
  ds_read_b64_tr_b16 v[52:53], v85 offset:4096
  ds_read_b64_tr_b16 v[54:55], v85 offset:4608
  ds_read_b128 v[20:23], v82 offset:36864
  v_mfma_f32_32x32x16_bf16 v[208:223], v[28:31], v[60:63], v[208:223]
  v_mfma_f32_32x32x16_bf16 v[192:207], v[24:27], v[60:63], v[192:207]
  s_waitcnt lgkmcnt(0)
  v_mfma_f32_32x32x16_bf16 v[160:175], v[16:19], v[48:51], v[160:175]
  ds_read_b64_tr_b16 v[56:57], v88 offset:2048
  ds_read_b64_tr_b16 v[58:59], v88 offset:2560
  ds_read_b128 v[24:27], v83 offset:32768
  s_waitcnt vmcnt(0)
  v_cmp_ne_u32 vcc, s73, v103
  v_cmp_ne_u32 s[86:87], s73, v107
  s_nop 0
  s_or_b64 vcc, vcc, s[86:87]
  s_cbranch_vccnz Lst_19
Lstok_20:
  v_cvt_pk_bf16_f32 v128, -v100, -v100
  v_cvt_pk_bf16_f32 v129, v102, v102
  v_mfma_f32_32x32x16_bf16 v[176:191], v[20:23], v[48:51], v[176:191]
  ds_read_b64_tr_b16 v[60:61], v88 offset:6144
  ds_read_b64_tr_b16 v[62:63], v88 offset:6656
  ds_read_b128 v[28:31], v83 offset:36864
  v_and_b32 v130, 0xffff0000, v128
  v_mfma_f32_32x32x16_bf16 v[208:223], v[20:23], v[52:55], v[208:223]
  v_and_b32 v131, 0xffff0000, v129
  v_sub_f32 v130, -v100, v130
  v_sub_f32 v132, v102, v131
  v_cvt_pk_bf16_f32 v130, v130, v131
  v_cvt_pk_bf16_f32 v132, v132, 0
  v_mfma_f32_16x16x32_bf16 v[68:71], v[64:67], v[48:51], v[68:71]
  v_mfma_f32_16x16x32_bf16 v[72:75], v[64:67], v[52:55], v[72:75]
  v_mfma_f32_32x32x16_bf16 v[192:207], v[16:19], v[52:55], v[192:207]
  v_cmp_gt_u32 vcc, 32, v1
  v_mov_b32 v115, 0
  s_nop 0
  v_cndmask_b32 v112, 0, v128, vcc
  v_cndmask_b32 v113, 0, v130, vcc
  v_cndmask_b32 v114, 0, v132, vcc
  v_cvt_pk_bf16_f32 v128, -v104, -v104
  s_waitcnt lgkmcnt(0)
  v_mfma_f32_32x32x16_bf16 v[160:175], v[24:27], v[56:59], v[160:175]
  s_barrier
  ds_read_b64_tr_b16 v[48:49], v86 offset:0
  ds_read_b64_tr_b16 v[50:51], v86 offset:512
  ds_read_b128 v[16:19], v80 offset:49152
  v_cvt_pk_bf16_f32 v129, v106, v106
  v_and_b32 v130, 0xffff0000, v128
  v_mfma_f32_32x32x16_bf16 v[176:191], v[28:31], v[56:59], v[176:191]
  ds_read_b64_tr_b16 v[52:53], v86 offset:4096
  ds_read_b64_tr_b16 v[54:55], v86 offset:4608
  ds_read_b128 v[20:23], v80 offset:53248
  v_and_b32 v131, 0xffff0000, v129
  v_sub_f32 v130, -v104, v130
  v_mfma_f32_32x32x16_bf16 v[208:223], v[28:31], v[60:63], v[208:223]
  v_sub_f32 v132, v106, v131
  v_cvt_pk_bf16_f32 v130, v130, v131
  v_cvt_pk_bf16_f32 v132, v132, 0
  v_mfma_f32_32x32x16_bf16 v[192:207], v[24:27], v[60:63], v[192:207]
  v_cmp_gt_u32 vcc, 32, v1
  v_mov_b32 v119, 0
  s_nop 0
  v_cndmask_b32 v116, 0, v128, vcc
  v_cndmask_b32 v117, 0, v130, vcc
  v_cndmask_b32 v118, 0, v132, vcc
  v_mul_f32 v120, 0x3fb8aa3b, v101
  s_waitcnt lgkmcnt(0)
  v_mfma_f32_32x32x16_bf16 v[160:175], v[16:19], v[48:51], v[160:175]
  ds_read_b64_tr_b16 v[56:57], v89 offset:2048
  ds_read_b64_tr_b16 v[58:59], v89 offset:2560
  ds_read_b128 v[24:27], v81 offset:49152
  v_mul_f32 v122, 0x358637bd, v102
  v_mul_f32 v121, 0x3fb8aa3b, v105
  v_mfma_f32_32x32x16_bf16 v[176:191], v[20:23], v[48:51], v[176:191]
  ds_read_b64_tr_b16 v[60:61], v89 offset:6144
  ds_read_b64_tr_b16 v[62:63], v89 offset:6656
  ds_read_b128 v[28:31], v81 offset:53248
  v_mul_f32 v123, 0x358637bd, v106
  v_mfma_f32_32x32x16_bf16 v[208:223], v[20:23], v[52:55], v[208:223]
  s_lshl_b32 s75, s64, 8
  s_add_u32 s75, s75, 157696
  v_lshl_add_u32 v8, v2, 2, s75
  v_lshl_add_u32 v6, v3, 4, s75
  ds_write_b32 v8, v120
  ds_write_b32 v8, v121 offset:128
  v_mfma_f32_16x16x32_bf16 v[68:71], v[64:67], v[48:51], v[68:71]
  v_mfma_f32_16x16x32_bf16 v[72:75], v[64:67], v[52:55], v[72:75]
  v_mfma_f32_32x32x16_bf16 v[192:207], v[16:19], v[52:55], v[192:207]
  s_mul_i32 s76, s64, 1280
  s_add_u32 s76, s76, 158720
  v_add_u32 v93, s76, v14
  v_xor_b32 v8, 16, v2
  v_lshl_add_u32 v8, v3, 4, v8
  v_lshlrev_b32 v9, 0, v3
  s_waitcnt lgkmcnt(2)
  v_mfma_f32_32x32x16_bf16 v[160:175], v[24:27], v[56:59], v[160:175]
  s_waitcnt lgkmcnt(0)
  s_barrier
  ds_read_b64_tr_b16 v[48:49], v84 offset:0
  ds_read_b64_tr_b16 v[50:51], v84 offset:512
  ds_read_b128 v[16:19], v82 offset:49152
  v_add_u32 v9, 32, v9
  v_cndmask_b32 v8, v8, v9, s[60:61]
  v_mfma_f32_32x32x16_bf16 v[176:191], v[28:31], v[56:59], v[176:191]
  ds_read_b64_tr_b16 v[52:53], v84 offset:4096
  ds_read_b64_tr_b16 v[54:55], v84 offset:4608
  ds_read_b128 v[20:23], v82 offset:53248
  v_lshl_add_u32 v90, v8, 5, s76
  v_mfma_f32_32x32x16_bf16 v[208:223], v[28:31], v[60:63], v[208:223]
  s_xor_b32 s76, s64, 2
  s_mul_i32 s76, s76, 1280
  s_add_u32 s76, s76, 158720
  v_add_u32 v92, s76, v14
  v_lshl_add_u32 v8, v3, 4, v2
  v_cndmask_b32 v8, v9, v8, s[60:61]
  v_mfma_f32_32x32x16_bf16 v[192:207], v[24:27], v[60:63], v[192:207]
  v_lshl_add_u32 v91, v8, 5, s76
  s_lshl_b32 s76, s64, 4
  s_add_u32 s76, s76, 155712
  v_mov_b32 v96, s76
  s_waitcnt lgkmcnt(0)
  v_mfma_f32_32x32x16_bf16 v[160:175], v[16:19], v[48:51], v[160:175]
  ds_read_b64_tr_b16 v[56:57], v87 offset:2048
  ds_read_b64_tr_b16 v[58:59], v87 offset:2560
  ds_read_b128 v[24:27], v83 offset:49152
  ds_read_b128 v[128:131], v6 offset:0
  ds_read_b128 v[132:135], v6 offset:32
  ds_read_b128 v[136:139], v6 offset:64
  v_mfma_f32_16x16x32_bf16 v[68:71], v[64:67], v[48:51], v[68:71]
  v_mfma_f32_16x16x32_bf16 v[72:75], v[64:67], v[52:55], v[72:75]
  v_mfma_f32_32x32x16_bf16 v[176:191], v[20:23], v[48:51], v[176:191]
  ds_read_b64_tr_b16 v[60:61], v87 offset:6144
  ds_read_b64_tr_b16 v[62:63], v87 offset:6656
  ds_read_b128 v[28:31], v83 offset:53248
  ds_read_b128 v[140:143], v6 offset:96
  ds_read_b128 v[32:35], v6 offset:128
  v_mfma_f32_32x32x16_bf16 v[208:223], v[20:23], v[52:55], v[208:223]
  ds_read_b128 v[36:39], v6 offset:160
  ds_read_b128 v[40:43], v6 offset:192
  ds_read_b128 v[44:47], v6 offset:224
  v_mov_b32 v156, 0x3f803f80
  v_mov_b32 v157, 0x3f803f80
  ds_write_b32 v94, v68 offset:0
  ds_write_b32 v94, v72 offset:128
  v_mfma_f32_32x32x16_bf16 v[192:207], v[16:19], v[52:55], v[192:207]
  v_mov_b32 v158, 0x3f803f80
  v_mov_b32 v159, 0x3f803f80
  v_xor_b32 v12, 32, v96
  s_waitcnt lgkmcnt(7)
  v_mfma_f32_32x32x16_bf16 v[160:175], v[24:27], v[56:59], v[160:175]
  s_waitcnt lgkmcnt(0)
  s_barrier
  ds_read_b32 v69, v95 offset:0
  ds_read_b32 v73, v95 offset:128
  v_mfma_f32_32x32x16_bf16 v[176:191], v[28:31], v[56:59], v[176:191]
  v_mfma_f32_32x32x16_bf16 v[192:207], v[24:27], v[60:63], v[192:207]
  v_mfma_f32_32x32x16_bf16 v[208:223], v[28:31], v[60:63], v[208:223]
  s_waitcnt lgkmcnt(0)
  v_add_f32 v68, v68, v69
  v_cvt_pk_bf16_f32 v69, v68, v68
  v_and_b32 v69, 0xffff0000, v69
  v_sub_f32 v70, v68, v69
  v_mov_b32 v155, 0
  v_cvt_pk_bf16_f32 v153, v69, 0
  v_mov_b32 v154, 0
  v_cvt_pk_bf16_f32 v152, v69, v70
  s_nop 1
  v_mfma_f32_32x32x16_bf16 v[160:175], v[112:115], v[152:155], v[160:175]
  v_mfma_f32_32x32x16_bf16 v[176:191], v[116:119], v[152:155], v[176:191]
  v_add_f32 v72, v72, v73
  v_cvt_pk_bf16_f32 v73, v72, v72
  v_and_b32 v73, 0xffff0000, v73
  v_sub_f32 v74, v72, v73
  v_mov_b32 v151, 0
  v_cvt_pk_bf16_f32 v149, v73, 0
  v_mov_b32 v150, 0
  v_cvt_pk_bf16_f32 v148, v73, v74
  s_nop 1
  v_mfma_f32_32x32x16_bf16 v[192:207], v[112:115], v[148:151], v[192:207]
  v_mfma_f32_32x32x16_bf16 v[208:223], v[116:119], v[148:151], v[208:223]
  v_pk_mul_f32 v[160:161], v[160:161], v[128:129]
  v_pk_mul_f32 v[162:163], v[162:163], v[130:131]
  v_pk_mul_f32 v[164:165], v[164:165], v[132:133]
  v_pk_mul_f32 v[166:167], v[166:167], v[134:135]
  v_exp_f32 v144, v160 clamp
  v_exp_f32 v145, v161 clamp
  v_exp_f32 v146, v162 clamp
  v_exp_f32 v147, v163 clamp
  v_exp_f32 v148, v164 clamp
  v_exp_f32 v149, v165 clamp
  v_exp_f32 v150, v166 clamp
  v_exp_f32 v151, v167 clamp
  v_max_f32 v160, v10, v160
  v_max_f32 v161, v10, v161
  v_max_f32 v162, v10, v162
  v_max_f32 v163, v10, v163
  v_max_f32 v164, v10, v164
  v_max_f32 v165, v10, v165
  v_max_f32 v166, v10, v166
  v_max_f32 v167, v10, v167
  v_pk_mul_f32 v[192:193], v[192:193], v[128:129]
  v_pk_mul_f32 v[194:195], v[194:195], v[130:131]
  v_pk_mul_f32 v[196:197], v[196:197], v[132:133]
  v_pk_mul_f32 v[198:199], v[198:199], v[134:135]
  v_pk_fma_f32 v[144:145], v[160:161], v[10:11], v[144:145] op_sel:[0,1,0] op_sel_hi:[1,1,1]
  v_pk_fma_f32 v[146:147], v[162:163], v[10:11], v[146:147] op_sel:[0,1,0] op_sel_hi:[1,1,1]
  v_pk_fma_f32 v[148:149], v[164:165], v[10:11], v[148:149] op_sel:[0,1,0] op_sel_hi:[1,1,1]
  v_pk_fma_f32 v[150:151], v[166:167], v[10:11], v[150:151] op_sel:[0,1,0] op_sel_hi:[1,1,1]
  v_cvt_pk_bf16_f32 v192, v192, v193
  v_cvt_pk_bf16_f32 v193, v194, v195
  v_cvt_pk_bf16_f32 v194, v196, v197
  v_cvt_pk_bf16_f32 v195, v198, v199
  v_cvt_pk_bf16_f32 v160, v144, v145
  v_cvt_pk_bf16_f32 v161, v146, v147
  v_cvt_pk_bf16_f32 v162, v148, v149
  v_cvt_pk_bf16_f32 v163, v150, v151
  v_pk_mul_f32 v[168:169], v[168:169], v[136:137]
  v_pk_mul_f32 v[170:171], v[170:171], v[138:139]
  v_pk_mul_f32 v[172:173], v[172:173], v[140:141]
  v_pk_mul_f32 v[174:175], v[174:175], v[142:143]
  v_mfma_f32_32x32x16_bf16 v[48:63], v[160:163], v[156:159], 0
  v_exp_f32 v144, v168 clamp
  v_exp_f32 v145, v169 clamp
  v_exp_f32 v146, v170 clamp
  v_exp_f32 v147, v171 clamp
  v_mfma_f32_32x32x16_bf16 v[16:31], v[160:163], v[192:195], 0
  v_exp_f32 v148, v172 clamp
  v_exp_f32 v149, v173 clamp
  v_exp_f32 v150, v174 clamp
  v_exp_f32 v151, v175 clamp
  v_max_f32 v168, v10, v168
  v_max_f32 v169, v10, v169
  v_max_f32 v170, v10, v170
  v_max_f32 v171, v10, v171
  v_max_f32 v172, v10, v172
  v_max_f32 v173, v10, v173
  v_max_f32 v174, v10, v174
  v_max_f32 v175, v10, v175
  v_pk_mul_f32 v[200:201], v[200:201], v[136:137]
  v_pk_mul_f32 v[202:203], v[202:203], v[138:139]
  v_pk_mul_f32 v[204:205], v[204:205], v[140:141]
  v_pk_mul_f32 v[206:207], v[206:207], v[142:143]
  v_pk_fma_f32 v[144:145], v[168:169], v[10:11], v[144:145] op_sel:[0,1,0] op_sel_hi:[1,1,1]
  v_pk_fma_f32 v[146:147], v[170:171], v[10:11], v[146:147] op_sel:[0,1,0] op_sel_hi:[1,1,1]
  v_pk_fma_f32 v[148:149], v[172:173], v[10:11], v[148:149] op_sel:[0,1,0] op_sel_hi:[1,1,1]
  v_pk_fma_f32 v[150:151], v[174:175], v[10:11], v[150:151] op_sel:[0,1,0] op_sel_hi:[1,1,1]
  v_cvt_pk_bf16_f32 v200, v200, v201
  v_cvt_pk_bf16_f32 v201, v202, v203
  v_cvt_pk_bf16_f32 v202, v204, v205
  v_cvt_pk_bf16_f32 v203, v206, v207
  v_cvt_pk_bf16_f32 v168, v144, v145
  v_cvt_pk_bf16_f32 v169, v146, v147
  v_cvt_pk_bf16_f32 v170, v148, v149
  v_cvt_pk_bf16_f32 v171, v150, v151
  v_pk_mul_f32 v[176:177], v[176:177], v[32:33]
  v_pk_mul_f32 v[178:179], v[178:179], v[34:35]
  v_pk_mul_f32 v[180:181], v[180:181], v[36:37]
  v_pk_mul_f32 v[182:183], v[182:183], v[38:39]
  v_mfma_f32_32x32x16_bf16 v[48:63], v[168:171], v[156:159], v[48:63]
  v_exp_f32 v144, v176 clamp
  v_exp_f32 v145, v177 clamp
  v_exp_f32 v146, v178 clamp
  v_exp_f32 v147, v179 clamp
  v_mfma_f32_32x32x16_bf16 v[16:31], v[168:171], v[200:203], v[16:31]
  v_exp_f32 v148, v180 clamp
  v_exp_f32 v149, v181 clamp
  v_exp_f32 v150, v182 clamp
  v_exp_f32 v151, v183 clamp
  v_max_f32 v176, v10, v176
  v_max_f32 v177, v10, v177
  v_max_f32 v178, v10, v178
  v_max_f32 v179, v10, v179
  v_max_f32 v180, v10, v180
  v_max_f32 v181, v10, v181
  v_max_f32 v182, v10, v182
  v_max_f32 v183, v10, v183
  v_pk_mul_f32 v[208:209], v[208:209], v[32:33]
  v_pk_mul_f32 v[210:211], v[210:211], v[34:35]
  v_pk_mul_f32 v[212:213], v[212:213], v[36:37]
  v_pk_mul_f32 v[214:215], v[214:215], v[38:39]
  v_pk_fma_f32 v[144:145], v[176:177], v[10:11], v[144:145] op_sel:[0,1,0] op_sel_hi:[1,1,1]
  v_pk_fma_f32 v[146:147], v[178:179], v[10:11], v[146:147] op_sel:[0,1,0] op_sel_hi:[1,1,1]
  v_pk_fma_f32 v[148:149], v[180:181], v[10:11], v[148:149] op_sel:[0,1,0] op_sel_hi:[1,1,1]
  v_pk_fma_f32 v[150:151], v[182:183], v[10:11], v[150:151] op_sel:[0,1,0] op_sel_hi:[1,1,1]
  v_cvt_pk_bf16_f32 v208, v208, v209
  v_cvt_pk_bf16_f32 v209, v210, v211
  v_cvt_pk_bf16_f32 v210, v212, v213
  v_cvt_pk_bf16_f32 v211, v214, v215
  v_cvt_pk_bf16_f32 v176, v144, v145
  v_cvt_pk_bf16_f32 v177, v146, v147
  v_cvt_pk_bf16_f32 v178, v148, v149
  v_cvt_pk_bf16_f32 v179, v150, v151
  v_pk_mul_f32 v[184:185], v[184:185], v[40:41]
  v_pk_mul_f32 v[186:187], v[186:187], v[42:43]
  v_pk_mul_f32 v[188:189], v[188:189], v[44:45]
  v_pk_mul_f32 v[190:191], v[190:191], v[46:47]
  v_mfma_f32_32x32x16_bf16 v[48:63], v[176:179], v[156:159], v[48:63]
  v_exp_f32 v144, v184 clamp
  v_exp_f32 v145, v185 clamp
  v_exp_f32 v146, v186 clamp
  v_exp_f32 v147, v187 clamp
  v_mfma_f32_32x32x16_bf16 v[16:31], v[176:179], v[208:211], v[16:31]
  v_exp_f32 v148, v188 clamp
  v_exp_f32 v149, v189 clamp
  v_exp_f32 v150, v190 clamp
  v_exp_f32 v151, v191 clamp
  v_max_f32 v184, v10, v184
  v_max_f32 v185, v10, v185
  v_max_f32 v186, v10, v186
  v_max_f32 v187, v10, v187
  v_max_f32 v188, v10, v188
  v_max_f32 v189, v10, v189
  v_max_f32 v190, v10, v190
  v_max_f32 v191, v10, v191
  v_pk_mul_f32 v[216:217], v[216:217], v[40:41]
  v_pk_mul_f32 v[218:219], v[218:219], v[42:43]
  v_pk_mul_f32 v[220:221], v[220:221], v[44:45]
  v_pk_mul_f32 v[222:223], v[222:223], v[46:47]
  v_pk_fma_f32 v[144:145], v[184:185], v[10:11], v[144:145] op_sel:[0,1,0] op_sel_hi:[1,1,1]
  v_pk_fma_f32 v[146:147], v[186:187], v[10:11], v[146:147] op_sel:[0,1,0] op_sel_hi:[1,1,1]
  v_pk_fma_f32 v[148:149], v[188:189], v[10:11], v[148:149] op_sel:[0,1,0] op_sel_hi:[1,1,1]
  v_pk_fma_f32 v[150:151], v[190:191], v[10:11], v[150:151] op_sel:[0,1,0] op_sel_hi:[1,1,1]
  v_cvt_pk_bf16_f32 v216, v216, v217
  v_cvt_pk_bf16_f32 v217, v218, v219
  v_cvt_pk_bf16_f32 v218, v220, v221
  v_cvt_pk_bf16_f32 v219, v222, v223
  v_cvt_pk_bf16_f32 v184, v144, v145
  v_cvt_pk_bf16_f32 v185, v146, v147
  v_cvt_pk_bf16_f32 v186, v148, v149
  v_cvt_pk_bf16_f32 v187, v150, v151
  s_nop 1
  v_mfma_f32_32x32x16_bf16 v[48:63], v[184:187], v[156:159], v[48:63]
  v_mfma_f32_32x32x16_bf16 v[16:31], v[184:187], v[216:219], v[16:31]
  v_mov_b32 v13, 1
  s_nop 10
  v_cndmask_b32 v144, v24, v56, s[60:61]
  v_cndmask_b32 v145, v25, v57, s[60:61]
  v_cndmask_b32 v146, v26, v58, s[60:61]
  v_cndmask_b32 v147, v27, v59, s[60:61]
  v_cndmask_b32 v148, v28, v60, s[60:61]
  v_cndmask_b32 v149, v29, v61, s[60:61]
  v_cndmask_b32 v150, v30, v62, s[60:61]
  v_cndmask_b32 v151, v31, v63, s[60:61]
  ds_write_b128 v90, v[144:147]
  ds_write_b128 v90, v[148:151] offset:16
  ds_write_b32 v96, v13
  v_cndmask_b32 v48, v48, v16, s[60:61]
  v_cndmask_b32 v49, v49, v17, s[60:61]
  v_cndmask_b32 v50, v50, v18, s[60:61]
  v_cndmask_b32 v51, v51, v19, s[60:61]
  v_cndmask_b32 v52, v52, v20, s[60:61]
  v_cndmask_b32 v53, v53, v21, s[60:61]
  v_cndmask_b32 v54, v54, v22, s[60:61]
  v_cndmask_b32 v55, v55, v23, s[60:61]
  s_mov_b32 s84, 0
Lpw_22:
  ds_read_b32 v13, v12 offset:0
  ds_read_b128 v[56:59], v91
  ds_read_b128 v[60:63], v91 offset:16
  s_add_u32 s84, s84, 1
  s_cmp_gt_u32 s84, 262144
  s_waitcnt lgkmcnt(0)
  s_cbranch_scc1 Lpwx_23
  v_cmp_eq_u32 vcc, 0, v13
  s_cbranch_vccnz Lpw_22
Lpwx_23:
  v_pk_add_f32 v[48:49], v[48:49], v[56:57]
  v_pk_add_f32 v[50:51], v[50:51], v[58:59]
  v_pk_add_f32 v[52:53], v[52:53], v[60:61]
  v_pk_add_f32 v[54:55], v[54:55], v[62:63]
  v_pk_mul_f32 v[48:49], v[48:49], v[0:1] op_sel_hi:[1,0]
  v_pk_mul_f32 v[50:51], v[50:51], v[0:1] op_sel_hi:[1,0]
  v_pk_mul_f32 v[52:53], v[52:53], v[0:1] op_sel_hi:[1,0]
  v_pk_mul_f32 v[54:55], v[54:55], v[0:1] op_sel_hi:[1,0]
  v_cvt_pk_bf16_f32 v144, v48, v49
  v_cvt_pk_bf16_f32 v145, v50, v51
  v_cvt_pk_bf16_f32 v146, v52, v53
  v_cvt_pk_bf16_f32 v147, v54, v55
  buffer_store_dwordx4 v[144:147], v15, s[44:47], s85 offen sc1
  ds_read_b64_tr_b16 v[48:49], v85 offset:0
  ds_read_b64_tr_b16 v[50:51], v85 offset:512
  ds_read_b128 v[16:19], v76 offset:0
  ds_read_b64_tr_b16 v[52:53], v88 offset:2048
  ds_read_b64_tr_b16 v[54:55], v88 offset:2560
  ds_read_b128 v[20:23], v76 offset:4096
  ds_read_b128 v[24:27], v77 offset:0
  ds_read_b128 v[28:31], v77 offset:4096
  s_waitcnt lgkmcnt(2)
  v_mfma_f32_32x32x16_bf16 v[224:239], v[48:51], v[16:19], 0
  ds_read_b64_tr_b16 v[56:57], v85 offset:4096
  ds_read_b64_tr_b16 v[58:59], v85 offset:4608
  ds_read_b128 v[32:35], v78 offset:0
  v_mfma_f32_32x32x16_bf16 v[240:255], v[48:51], v[20:23], 0
  ds_read_b64_tr_b16 v[60:61], v88 offset:6144
  ds_read_b64_tr_b16 v[62:63], v88 offset:6656
  ds_read_b128 v[36:39], v78 offset:4096
  s_waitcnt lgkmcnt(6)
  v_mfma_f32_32x32x16_bf16 v[240:255], v[52:55], v[28:31], v[240:255]
  ds_read_b128 v[40:43], v79 offset:0
  v_mfma_f32_16x16x32_bf16 v[68:71], v[64:67], v[48:51], 0
  v_mfma_f32_32x32x16_bf16 v[224:239], v[52:55], v[24:27], v[224:239]
  ds_read_b128 v[44:47], v79 offset:4096
  s_waitcnt lgkmcnt(2)
  v_mfma_f32_32x32x16_bf16 v[224:239], v[56:59], v[32:35], v[224:239]
  s_barrier
  ds_read_b64_tr_b16 v[48:49], v86 offset:0
  ds_read_b64_tr_b16 v[50:51], v86 offset:512
  ds_read_b128 v[16:19], v76 offset:16384
  v_mfma_f32_32x32x16_bf16 v[240:255], v[56:59], v[36:39], v[240:255]
  ds_read_b64_tr_b16 v[52:53], v89 offset:2048
  ds_read_b64_tr_b16 v[54:55], v89 offset:2560
  ds_read_b128 v[20:23], v76 offset:20480
  s_waitcnt lgkmcnt(6)
  v_mfma_f32_32x32x16_bf16 v[240:255], v[60:63], v[44:47], v[240:255]
  ds_read_b128 v[24:27], v77 offset:16384
  v_mfma_f32_16x16x32_bf16 v[68:71], v[64:67], v[56:59], v[68:71]
  v_mfma_f32_32x32x16_bf16 v[224:239], v[60:63], v[40:43], v[224:239]
  ds_read_b128 v[28:31], v77 offset:20480
  s_waitcnt lgkmcnt(2)
  v_mfma_f32_32x32x16_bf16 v[224:239], v[48:51], v[16:19], v[224:239]
  ds_read_b64_tr_b16 v[56:57], v86 offset:4096
  ds_read_b64_tr_b16 v[58:59], v86 offset:4608
  ds_read_b128 v[32:35], v78 offset:16384
  v_mfma_f32_32x32x16_bf16 v[240:255], v[48:51], v[20:23], v[240:255]
  ds_read_b64_tr_b16 v[60:61], v89 offset:6144
  ds_read_b64_tr_b16 v[62:63], v89 offset:6656
  ds_read_b128 v[36:39], v78 offset:20480
  s_waitcnt lgkmcnt(6)
  v_mfma_f32_32x32x16_bf16 v[240:255], v[52:55], v[28:31], v[240:255]
  ds_read_b128 v[40:43], v79 offset:16384
  v_mfma_f32_16x16x32_bf16 v[68:71], v[64:67], v[48:51], v[68:71]
  v_mfma_f32_32x32x16_bf16 v[224:239], v[52:55], v[24:27], v[224:239]
  ds_read_b128 v[44:47], v79 offset:20480
  s_waitcnt lgkmcnt(2)
  v_mfma_f32_32x32x16_bf16 v[224:239], v[56:59], v[32:35], v[224:239]
  s_barrier
  ds_read_b64_tr_b16 v[48:49], v84 offset:0
  ds_read_b64_tr_b16 v[50:51], v84 offset:512
  ds_read_b128 v[16:19], v76 offset:32768
  s_waitcnt vmcnt(0)
  v_mov_b32 v11, s73
  buffer_store_dword v11, v7, s[44:47], s3 offen sc1
  s_mov_b32 s52, s20
  s_mov_b32 s53, s21
  s_mov_b32 s54, 2097152
  s_mov_b32 s55, 0x00020000
  v_mfma_f32_32x32x16_bf16 v[240:255], v[56:59], v[36:39], v[240:255]
  ds_read_b64_tr_b16 v[52:53], v87 offset:2048
  ds_read_b64_tr_b16 v[54:55], v87 offset:2560
  ds_read_b128 v[20:23], v76 offset:36864
  s_mov_b32 s60, s18
  s_mov_b32 s61, s19
  s_mov_b32 s62, 1024
  s_mov_b32 s63, 0x00020000
  s_waitcnt lgkmcnt(6)
  v_mfma_f32_32x32x16_bf16 v[240:255], v[60:63], v[44:47], v[240:255]
  ds_read_b128 v[24:27], v77 offset:32768
  s_lshl_b32 s12, s65, 1
  s_add_u32 s12, s12, s68
  s_lshl_b32 s13, s12, 2
  s_add_u32 s13, s13, s64
  s_lshl_b32 s70, s13, 16
  v_lshlrev_b32 v150, 4, v1
  v_lshrrev_b32 v8, 2, v5
  v_mfma_f32_16x16x32_bf16 v[68:71], v[64:67], v[56:59], v[68:71]
  v_mfma_f32_32x32x16_bf16 v[224:239], v[60:63], v[40:43], v[224:239]
  ds_read_b128 v[28:31], v77 offset:36864
  v_lshl_add_u32 v8, v3, 2, v8
  s_lshl_b32 s13, s72, 4
  v_add_u32 v8, s13, v8
  v_lshlrev_b32 v8, 7, v8
  v_and_b32 v9, 1, v5
  s_waitcnt lgkmcnt(2)
  v_mfma_f32_32x32x16_bf16 v[224:239], v[48:51], v[16:19], v[224:239]
  ds_read_b64_tr_b16 v[56:57], v84 offset:4096
  ds_read_b64_tr_b16 v[58:59], v84 offset:4608
  ds_read_b128 v[32:35], v78 offset:32768
  v_lshl_add_u32 v8, v9, 3, v8
  v_and_b32 v9, 1, v4
  v_lshlrev_b32 v9, 1, v9
  v_bfe_u32 v0, v5, 1, 1
  v_mfma_f32_32x32x16_bf16 v[240:255], v[48:51], v[20:23], v[240:255]
  ds_read_b64_tr_b16 v[60:61], v87 offset:6144
  ds_read_b64_tr_b16 v[62:63], v87 offset:6656
  ds_read_b128 v[36:39], v78 offset:36864
  v_add_u32 v9, v9, v0
  v_lshrrev_b32 v0, 3, v5
  v_lshlrev_b32 v0, 2, v0
  v_xor_b32 v9, v9, v0
  s_waitcnt lgkmcnt(6)
  v_mfma_f32_32x32x16_bf16 v[240:255], v[52:55], v[28:31], v[240:255]
  ds_read_b128 v[40:43], v79 offset:32768
  s_lshl_b32 s13, s72, 2
  v_xor_b32 v9, s13, v9
  v_lshl_add_u32 v144, v9, 4, v8
  v_xor_b32 v9, 4, v9
  v_lshl_add_u32 v145, v9, 4, v8
  v_add_u32 v146, 65536, v144
  v_mfma_f32_16x16x32_bf16 v[68:71], v[64:67], v[48:51], v[68:71]
  v_mfma_f32_32x32x16_bf16 v[224:239], v[52:55], v[24:27], v[224:239]
  ds_read_b128 v[44:47], v79 offset:36864
  v_add_u32 v147, 65536, v145
  v_add_u32 v148, 131072, v144
  v_add_u32 v149, 131072, v145
  s_lshl_b32 s13, s64, 12
  s_add_u32 s13, s13, 86016
  v_add_u32 v151, s13, v150
  s_waitcnt lgkmcnt(2)
  v_mfma_f32_32x32x16_bf16 v[224:239], v[56:59], v[32:35], v[224:239]
  s_barrier
  ds_read_b64_tr_b16 v[48:49], v85 offset:0
  ds_read_b64_tr_b16 v[50:51], v85 offset:512
  ds_read_b128 v[16:19], v76 offset:49152
  s_xor_b32 s13, s64, 1
  s_lshl_b32 s13, s13, 12
  s_add_u32 s13, s13, 86016
  v_add_u32 v152, s13, v150
  v_mfma_f32_32x32x16_bf16 v[240:255], v[56:59], v[36:39], v[240:255]
  ds_read_b64_tr_b16 v[52:53], v88 offset:2048
  ds_read_b64_tr_b16 v[54:55], v88 offset:2560
  ds_read_b128 v[20:23], v76 offset:53248
  v_and_b32 v8, 3, v1
  v_lshlrev_b32 v8, 2, v8
  v_add_u32 v154, 155776, v8
  s_waitcnt lgkmcnt(6)
  v_mfma_f32_32x32x16_bf16 v[240:255], v[60:63], v[44:47], v[240:255]
  ds_read_b128 v[24:27], v77 offset:49152
  v_lshlrev_b32 v0, 7, v5
  s_lshl_b32 s13, s64, 2
  s_add_u32 s13, s13, 155792
  v_mov_b32 v155, s13
  s_lshl_b32 s13, s64, 4
  s_add_u32 s13, s13, 155712
  v_mov_b32 v157, s13
  v_mfma_f32_16x16x32_bf16 v[68:71], v[64:67], v[56:59], v[68:71]
  v_mfma_f32_32x32x16_bf16 v[224:239], v[60:63], v[40:43], v[224:239]
  ds_read_b128 v[28:31], v77 offset:53248
  s_xor_b32 s13, s13, 16
  v_mov_b32 v156, s13
  s_lshl_b32 s82, s12, 11
  s_add_u32 s82, s82, 9109504
  s_mov_b32 s14, s69
  s_waitcnt lgkmcnt(2)
  v_mfma_f32_32x32x16_bf16 v[224:239], v[48:51], v[16:19], v[224:239]
  ds_read_b64_tr_b16 v[56:57], v85 offset:4096
  ds_read_b64_tr_b16 v[58:59], v85 offset:4608
  ds_read_b128 v[32:35], v78 offset:49152
  s_lshr_b32 s13, s2, 6
  s_mul_i32 s13, s13, 1
  s_add_u32 s13, s13, s69
  v_mfma_f32_32x32x16_bf16 v[240:255], v[48:51], v[20:23], v[240:255]
  ds_read_b64_tr_b16 v[60:61], v88 offset:6144
  ds_read_b64_tr_b16 v[62:63], v88 offset:6656
  ds_read_b128 v[36:39], v78 offset:53248
  s_mul_i32 s15, s13, 128
  s_lshr_b32 s15, s15, 8
  s_mul_i32 s15, s15, 2
  s_sub_u32 s13, s13, s15
  s_waitcnt lgkmcnt(6)
  v_mfma_f32_32x32x16_bf16 v[240:255], v[52:55], v[28:31], v[240:255]
  ds_read_b128 v[40:43], v79 offset:49152
  s_sub_u32 s13, s69, s13
  s_add_u32 s15, s13, 2
  s_cmp_lt_i32 s13, 1
  s_cselect_b32 s13, s15, s13
  s_sub_u32 s15, s69, 1
  s_cmp_lt_u32 s15, 2
  s_cselect_b32 s14, s13, s14
  v_mfma_f32_16x16x32_bf16 v[68:71], v[64:67], v[48:51], v[68:71]
  v_mfma_f32_32x32x16_bf16 v[224:239], v[52:55], v[24:27], v[224:239]
  ds_read_b128 v[44:47], v79 offset:53248
  s_lshr_b32 s13, s2, 6
  s_mul_i32 s13, s13, 1
  s_add_u32 s13, s13, s69
  s_mul_i32 s15, s13, 128
  s_lshr_b32 s15, s15, 8
  s_mul_i32 s15, s15, 2
  s_sub_u32 s13, s13, s15
  s_waitcnt lgkmcnt(2)
  v_mfma_f32_32x32x16_bf16 v[224:239], v[56:59], v[32:35], v[224:239]
  s_barrier
  ds_read_b64_tr_b16 v[48:49], v86 offset:0
  ds_read_b64_tr_b16 v[50:51], v86 offset:512
  ds_read_b128 v[16:19], v80 offset:0
  s_sub_u32 s13, s69, s13
  s_add_u32 s15, s13, 2
  s_cmp_lt_i32 s13, 3
  s_cselect_b32 s13, s15, s13
  v_mfma_f32_32x32x16_bf16 v[240:255], v[56:59], v[36:39], v[240:255]
  ds_read_b64_tr_b16 v[52:53], v89 offset:2048
  ds_read_b64_tr_b16 v[54:55], v89 offset:2560
  ds_read_b128 v[20:23], v80 offset:4096
  s_sub_u32 s15, s69, 3
  s_cmp_lt_u32 s15, 2
  s_cselect_b32 s14, s13, s14
  s_waitcnt lgkmcnt(6)
  v_mfma_f32_32x32x16_bf16 v[240:255], v[60:63], v[44:47], v[240:255]
  ds_read_b128 v[24:27], v81 offset:0
  s_lshr_b32 s13, s2, 6
  s_mul_i32 s13, s13, 1
  s_add_u32 s13, s13, s69
  s_mul_i32 s15, s13, 86
  s_lshr_b32 s15, s15, 8
  s_mul_i32 s15, s15, 3
  s_sub_u32 s13, s13, s15
  v_mfma_f32_16x16x32_bf16 v[68:71], v[64:67], v[56:59], v[68:71]
  v_mfma_f32_32x32x16_bf16 v[224:239], v[60:63], v[40:43], v[224:239]
  ds_read_b128 v[28:31], v81 offset:4096
  s_sub_u32 s13, s69, s13
  s_add_u32 s15, s13, 3
  s_cmp_lt_i32 s13, 5
  s_cselect_b32 s13, s15, s13
  s_waitcnt lgkmcnt(2)
  v_mfma_f32_32x32x16_bf16 v[224:239], v[48:51], v[16:19], v[224:239]
  ds_read_b64_tr_b16 v[56:57], v86 offset:4096
  ds_read_b64_tr_b16 v[58:59], v86 offset:4608
  ds_read_b128 v[32:35], v82 offset:0
  s_sub_u32 s15, s69, 5
  s_cmp_lt_u32 s15, 3
  s_cselect_b32 s14, s13, s14
  s_lshl_b32 s14, s14, 2
  s_lshl_b32 s13, s68, 1
  s_add_u32 s14, s14, s13
  s_add_u32 s14, s14, s71
  s_lshl_b32 s14, s14, 12
  v_mfma_f32_32x32x16_bf16 v[240:255], v[48:51], v[20:23], v[240:255]
  ds_read_b64_tr_b16 v[60:61], v89 offset:6144
  ds_read_b64_tr_b16 v[62:63], v89 offset:6656
  ds_read_b128 v[36:39], v82 offset:4096
  v_bfe_u32 v8, v1, 1, 3
  s_waitcnt lgkmcnt(6)
  v_mfma_f32_32x32x16_bf16 v[240:255], v[52:55], v[28:31], v[240:255]
  ds_read_b128 v[40:43], v83 offset:0
  s_lshl_b32 s13, s72, 2
  v_xor_b32 v8, s13, v8
  v_lshlrev_b32 v8, 4, v8
  v_lshl_add_u32 v8, v3, 3, v8
  v_lshl_add_u32 v8, v2, 7, v8
  v_add_u32 v124, s14, v8
  v_mfma_f32_16x16x32_bf16 v[68:71], v[64:67], v[48:51], v[68:71]
  v_mfma_f32_32x32x16_bf16 v[224:239], v[52:55], v[24:27], v[224:239]
  ds_read_b128 v[44:47], v83 offset:4096
  s_lshl_b32 s12, s12, 1
  s_add_u32 s12, s12, s71
  s_lshl_b32 s12, s12, 15
  s_lshl_b32 s13, s69, 1
  s_add_u32 s13, s13, s72
  s_lshl_b32 s13, s13, 6
  s_add_u32 s12, s12, s13
  s_waitcnt lgkmcnt(2)
  v_mfma_f32_32x32x16_bf16 v[224:239], v[56:59], v[32:35], v[224:239]
  s_barrier
  ds_read_b64_tr_b16 v[48:49], v84 offset:0
  ds_read_b64_tr_b16 v[50:51], v84 offset:512
  ds_read_b128 v[16:19], v80 offset:16384
  v_lshl_add_u32 v8, v2, 10, s12
  v_lshl_add_u32 v153, v3, 4, v8
  s_mov_b32 s83, s13
  v_mfma_f32_32x32x16_bf16 v[240:255], v[56:59], v[36:39], v[240:255]
  ds_read_b64_tr_b16 v[52:53], v87 offset:2048
  ds_read_b64_tr_b16 v[54:55], v87 offset:2560
  ds_read_b128 v[20:23], v80 offset:20480
  s_lshl_b32 s76, s65, 1
  s_add_u32 s76, s76, s68
  s_mul_i32 s81, s76, 6144
  s_add_u32 s81, s81, 8912896
  s_waitcnt lgkmcnt(6)
  v_mfma_f32_32x32x16_bf16 v[240:255], v[60:63], v[44:47], v[240:255]
  ds_read_b128 v[24:27], v81 offset:16384
  v_lshlrev_b32 v0, 7, v5
  v_mul_u32_u24 v97, 640, v3
  v_lshl_add_u32 v97, v2, 4, v97
  v_and_b32 v8, 7, v5
  v_lshl_add_u32 v8, v8, 1, v3
  v_mfma_f32_16x16x32_bf16 v[68:71], v[64:67], v[56:59], v[68:71]
  v_mfma_f32_32x32x16_bf16 v[224:239], v[60:63], v[40:43], v[224:239]
  ds_read_b128 v[28:31], v81 offset:20480
  v_mul_u32_u24 v98, 640, v8
  v_and_b32 v9, 1, v4
  v_lshl_add_u32 v98, v9, 6, v98
  v_add_u32 v98, 512, v98
  s_waitcnt lgkmcnt(2)
  v_mfma_f32_32x32x16_bf16 v[224:239], v[48:51], v[16:19], v[224:239]
  ds_read_b64_tr_b16 v[56:57], v84 offset:4096
  ds_read_b64_tr_b16 v[58:59], v84 offset:4608
  ds_read_b128 v[32:35], v82 offset:16384
  s_xor_b32 s76, s64, 2
  s_mul_i32 s76, s76, 1280
  s_add_u32 s76, s76, 158720
  v_lshl_add_u32 v8, v3, 3, s76
  v_lshl_add_u32 v90, v2, 4, v8
  v_mfma_f32_32x32x16_bf16 v[240:255], v[48:51], v[20:23], v[240:255]
  ds_read_b64_tr_b16 v[60:61], v87 offset:6144
  ds_read_b64_tr_b16 v[62:63], v87 offset:6656
  ds_read_b128 v[36:39], v82 offset:20480
  v_lshl_add_u32 v91, v9, 6, v8
  v_add_u32 v91, 512, v91
  s_waitcnt lgkmcnt(6)
  v_mfma_f32_32x32x16_bf16 v[240:255], v[52:55], v[28:31], v[240:255]
  ds_read_b128 v[40:43], v83 offset:16384
  s_lshl_b32 s7, s65, 1
  s_add_u32 s7, s7, s71
  s_lshl_b32 s7, s7, 18
  s_lshl_b32 s75, s66, 1
  s_add_u32 s75, s75, s72
  s_add_u32 s80, s75, 43
  s_lshl_b32 s80, s80, 10
  s_add_u32 s7, s7, s80
  v_mfma_f32_16x16x32_bf16 v[68:71], v[64:67], v[48:51], v[68:71]
  v_mfma_f32_32x32x16_bf16 v[224:239], v[52:55], v[24:27], v[224:239]
  ds_read_b128 v[44:47], v83 offset:20480
  s_lshl_b32 s76, s65, 1
  s_add_u32 s76, s76, s71
  s_lshl_b32 s6, s76, 11
  s_lshl_b32 s76, s75, 7
  s_add_u32 s6, s6, s76
  s_add_u32 s6, s6, 9109504
  s_waitcnt lgkmcnt(2)
  v_mfma_f32_32x32x16_bf16 v[224:239], v[56:59], v[32:35], v[224:239]
  s_barrier
  ds_read_b64_tr_b16 v[48:49], v85 offset:0
  ds_read_b64_tr_b16 v[50:51], v85 offset:512
  ds_read_b128 v[16:19], v80 offset:32768
  s_lshl_b32 s4, s71, 16
  s_xor_b32 s5, s4, 65536
  s_add_u32 s4, s4, s7
  s_add_u32 s5, s5, s7
  v_mfma_f32_32x32x16_bf16 v[240:255], v[56:59], v[36:39], v[240:255]
  ds_read_b64_tr_b16 v[52:53], v88 offset:2048
  ds_read_b64_tr_b16 v[54:55], v88 offset:2560
  ds_read_b128 v[20:23], v80 offset:36864
  s_waitcnt lgkmcnt(6)
  v_mfma_f32_32x32x16_bf16 v[240:255], v[60:63], v[44:47], v[240:255]
  ds_read_b128 v[24:27], v81 offset:32768
  v_mfma_f32_16x16x32_bf16 v[68:71], v[64:67], v[56:59], v[68:71]
  v_mfma_f32_32x32x16_bf16 v[224:239], v[60:63], v[40:43], v[224:239]
  ds_read_b128 v[28:31], v81 offset:36864
  s_waitcnt lgkmcnt(2)
  v_mfma_f32_32x32x16_bf16 v[224:239], v[48:51], v[16:19], v[224:239]
  ds_read_b64_tr_b16 v[56:57], v85 offset:4096
  ds_read_b64_tr_b16 v[58:59], v85 offset:4608
  ds_read_b128 v[32:35], v82 offset:32768
  v_mfma_f32_32x32x16_bf16 v[240:255], v[48:51], v[20:23], v[240:255]
  ds_read_b64_tr_b16 v[60:61], v88 offset:6144
  ds_read_b64_tr_b16 v[62:63], v88 offset:6656
  ds_read_b128 v[36:39], v82 offset:36864
  s_waitcnt lgkmcnt(6)
  v_mfma_f32_32x32x16_bf16 v[240:255], v[52:55], v[28:31], v[240:255]
  ds_read_b128 v[40:43], v83 offset:32768
  v_mfma_f32_16x16x32_bf16 v[68:71], v[64:67], v[48:51], v[68:71]
  v_mfma_f32_32x32x16_bf16 v[224:239], v[52:55], v[24:27], v[224:239]
  ds_read_b128 v[44:47], v83 offset:36864
  s_waitcnt lgkmcnt(2)
  v_mfma_f32_32x32x16_bf16 v[224:239], v[56:59], v[32:35], v[224:239]
  s_barrier
  ds_read_b64_tr_b16 v[48:49], v86 offset:0
  ds_read_b64_tr_b16 v[50:51], v86 offset:512
  ds_read_b128 v[16:19], v80 offset:49152
  buffer_load_dword v11, v0, s[44:47], s27 offen sc1
  v_mfma_f32_32x32x16_bf16 v[240:255], v[56:59], v[36:39], v[240:255]
  ds_read_b64_tr_b16 v[52:53], v89 offset:2048
  ds_read_b64_tr_b16 v[54:55], v89 offset:2560
  ds_read_b128 v[20:23], v80 offset:53248
  s_waitcnt lgkmcnt(6)
  v_mfma_f32_32x32x16_bf16 v[240:255], v[60:63], v[44:47], v[240:255]
  ds_read_b128 v[24:27], v81 offset:49152
  v_mfma_f32_16x16x32_bf16 v[68:71], v[64:67], v[56:59], v[68:71]
  v_mfma_f32_32x32x16_bf16 v[224:239], v[60:63], v[40:43], v[224:239]
  ds_read_b128 v[28:31], v81 offset:53248
  s_waitcnt lgkmcnt(2)
  v_mfma_f32_32x32x16_bf16 v[224:239], v[48:51], v[16:19], v[224:239]
  ds_read_b64_tr_b16 v[56:57], v86 offset:4096
  ds_read_b64_tr_b16 v[58:59], v86 offset:4608
  ds_read_b128 v[32:35], v82 offset:49152
  v_mfma_f32_32x32x16_bf16 v[240:255], v[48:51], v[20:23], v[240:255]
  ds_read_b64_tr_b16 v[60:61], v89 offset:6144
  ds_read_b64_tr_b16 v[62:63], v89 offset:6656
  ds_read_b128 v[36:39], v82 offset:53248
  s_waitcnt lgkmcnt(6)
  v_mfma_f32_32x32x16_bf16 v[240:255], v[52:55], v[28:31], v[240:255]
  ds_read_b128 v[40:43], v83 offset:49152
  v_mfma_f32_16x16x32_bf16 v[68:71], v[64:67], v[48:51], v[68:71]
  v_mfma_f32_32x32x16_bf16 v[224:239], v[52:55], v[24:27], v[224:239]
  ds_read_b128 v[44:47], v83 offset:53248
  s_waitcnt lgkmcnt(2)
  v_mfma_f32_16x16x32_bf16 v[68:71], v[64:67], v[56:59], v[68:71]
  v_mfma_f32_32x32x16_bf16 v[224:239], v[56:59], v[32:35], v[224:239]
  ds_read_b64 v[76:77], v124
  v_xor_b32 v8, 16, v124
  ds_read_b64 v[78:79], v8
  v_xor_b32 v8, 32, v124
  ds_read_b64 v[80:81], v8
  v_xor_b32 v8, 48, v124
  ds_read_b64 v[82:83], v8
  v_mfma_f32_32x32x16_bf16 v[240:255], v[56:59], v[36:39], v[240:255]
  ds_write_b32 v94, v68 offset:256
  s_waitcnt lgkmcnt(5)
  v_mfma_f32_32x32x16_bf16 v[240:255], v[60:63], v[44:47], v[240:255]
  s_waitcnt lgkmcnt(0)
  s_barrier
  ds_read_b32 v69, v95 offset:256
  v_mfma_f32_32x32x16_bf16 v[224:239], v[60:63], v[40:43], v[224:239]
  s_waitcnt lgkmcnt(0)
  v_add_f32 v68, v68, v69
  v_cvt_pk_bf16_f32 v69, v68, v68
  v_and_b32 v69, 0xffff0000, v69
  v_sub_f32 v70, v68, v69
  v_mov_b32 v131, 0
  v_cvt_pk_bf16_f32 v129, v69, 0
  v_mov_b32 v130, 0
  v_cvt_pk_bf16_f32 v128, v69, v70
  s_nop 1
  v_mfma_f32_32x32x16_bf16 v[224:239], v[128:131], v[112:115], v[224:239]
  v_mfma_f32_32x32x16_bf16 v[240:255], v[128:131], v[116:119], v[240:255]
  s_waitcnt vmcnt(0)
  v_cmp_ne_u32 vcc, s73, v11
  s_cbranch_vccnz Lkf_24
Lkfok_25:
  buffer_load_dwordx4 v[192:195], v98, s[44:47], s26 offen sc1
  s_add_u32 s3, s26, 0
  buffer_load_dwordx4 v[160:163], v97, s[44:47], s3 offen offset:0 sc1
  buffer_load_dwordx4 v[164:167], v97, s[44:47], s3 offen offset:1280 sc1
  buffer_load_dwordx4 v[168:171], v97, s[44:47], s3 offen offset:2560 sc1
  buffer_load_dwordx4 v[172:175], v97, s[44:47], s3 offen offset:3840 sc1
  s_add_u32 s3, s26, 5120
  buffer_load_dwordx4 v[176:179], v97, s[44:47], s3 offen offset:0 sc1
  buffer_load_dwordx4 v[180:183], v97, s[44:47], s3 offen offset:1280 sc1
  buffer_load_dwordx4 v[184:187], v97, s[44:47], s3 offen offset:2560 sc1
  buffer_load_dwordx4 v[188:191], v97, s[44:47], s3 offen offset:3840 sc1
  buffer_load_dword v158, v0, s[44:47], s81 offen sc1
  s_mov_b32 s27, s6
  v_lshlrev_b32 v10, 4, v1
  v_mov_b32 v13, 1
  v_mul_f32 v128, v120, v224
  v_mul_f32 v129, v120, v225
  v_mul_f32 v130, v120, v226
  v_mul_f32 v131, v120, v227
  v_mul_f32 v132, v120, v228
  v_mul_f32 v133, v120, v229
  v_mul_f32 v134, v120, v230
  v_mul_f32 v135, v120, v231
  v_exp_f32 v128, v128 clamp
  v_exp_f32 v129, v129 clamp
  v_exp_f32 v130, v130 clamp
  v_exp_f32 v131, v131 clamp
  v_exp_f32 v132, v132 clamp
  v_exp_f32 v133, v133 clamp
  v_exp_f32 v134, v134 clamp
  v_exp_f32 v135, v135 clamp
  v_max_f32 v224, v122, v224
  v_max_f32 v225, v122, v225
  v_max_f32 v226, v122, v226
  v_max_f32 v227, v122, v227
  v_max_f32 v228, v122, v228
  v_max_f32 v229, v122, v229
  v_max_f32 v230, v122, v230
  v_max_f32 v231, v122, v231
  v_fmac_f32 v128, v224, v101
  v_fmac_f32 v129, v225, v101
  v_fmac_f32 v130, v226, v101
  v_fmac_f32 v131, v227, v101
  v_fmac_f32 v132, v228, v101
  v_fmac_f32 v133, v229, v101
  v_fmac_f32 v134, v230, v101
  v_fmac_f32 v135, v231, v101
  v_cvt_pk_bf16_f32 v224, v128, v129
  v_cvt_pk_bf16_f32 v225, v130, v131
  v_cvt_pk_bf16_f32 v226, v132, v133
  v_cvt_pk_bf16_f32 v227, v134, v135
  v_mul_f32 v128, v120, v232
  v_mul_f32 v129, v120, v233
  v_mul_f32 v130, v120, v234
  v_mul_f32 v131, v120, v235
  v_mul_f32 v132, v120, v236
  v_mul_f32 v133, v120, v237
  v_mul_f32 v134, v120, v238
  v_mul_f32 v135, v120, v239
  v_exp_f32 v128, v128 clamp
  v_exp_f32 v129, v129 clamp
  v_exp_f32 v130, v130 clamp
  v_exp_f32 v131, v131 clamp
  v_exp_f32 v132, v132 clamp
  v_exp_f32 v133, v133 clamp
  v_exp_f32 v134, v134 clamp
  v_exp_f32 v135, v135 clamp
  v_max_f32 v232, v122, v232
  v_max_f32 v233, v122, v233
  v_max_f32 v234, v122, v234
  v_max_f32 v235, v122, v235
  v_max_f32 v236, v122, v236
  v_max_f32 v237, v122, v237
  v_max_f32 v238, v122, v238
  v_max_f32 v239, v122, v239
  v_fmac_f32 v128, v232, v101
  v_fmac_f32 v129, v233, v101
  v_fmac_f32 v130, v234, v101
  v_fmac_f32 v131, v235, v101
  v_fmac_f32 v132, v236, v101
  v_fmac_f32 v133, v237, v101
  v_fmac_f32 v134, v238, v101
  v_fmac_f32 v135, v239, v101
  v_cvt_pk_bf16_f32 v232, v128, v129
  v_cvt_pk_bf16_f32 v233, v130, v131
  v_cvt_pk_bf16_f32 v234, v132, v133
  v_cvt_pk_bf16_f32 v235, v134, v135
  v_mul_f32 v128, v121, v240
  v_mul_f32 v129, v121, v241
  v_mul_f32 v130, v121, v242
  v_mul_f32 v131, v121, v243
  v_mul_f32 v132, v121, v244
  v_mul_f32 v133, v121, v245
  v_mul_f32 v134, v121, v246
  v_mul_f32 v135, v121, v247
  v_exp_f32 v128, v128 clamp
  v_exp_f32 v129, v129 clamp
  v_exp_f32 v130, v130 clamp
  v_exp_f32 v131, v131 clamp
  v_exp_f32 v132, v132 clamp
  v_exp_f32 v133, v133 clamp
  v_exp_f32 v134, v134 clamp
  v_exp_f32 v135, v135 clamp
  v_max_f32 v240, v123, v240
  v_max_f32 v241, v123, v241
  v_max_f32 v242, v123, v242
  v_max_f32 v243, v123, v243
  v_max_f32 v244, v123, v244
  v_max_f32 v245, v123, v245
  v_max_f32 v246, v123, v246
  v_max_f32 v247, v123, v247
  v_fmac_f32 v128, v240, v105
  v_fmac_f32 v129, v241, v105
  v_fmac_f32 v130, v242, v105
  v_fmac_f32 v131, v243, v105
  v_fmac_f32 v132, v244, v105
  v_fmac_f32 v133, v245, v105
  v_fmac_f32 v134, v246, v105
  v_fmac_f32 v135, v247, v105
  v_cvt_pk_bf16_f32 v240, v128, v129
  v_cvt_pk_bf16_f32 v241, v130, v131
  v_cvt_pk_bf16_f32 v242, v132, v133
  v_cvt_pk_bf16_f32 v243, v134, v135
  s_waitcnt vmcnt(9)
  v_mfma_f32_16x16x32_bf16 v[204:207], v[108:111], v[192:195], 0
  s_waitcnt vmcnt(8)
  v_mfma_f32_16x16x32_bf16 v[200:203], v[108:111], v[160:163], 0
  s_waitcnt vmcnt(7)
  v_mfma_f32_16x16x32_bf16 v[200:203], v[108:111], v[164:167], v[200:203]
  s_waitcnt vmcnt(6)
  v_mfma_f32_16x16x32_bf16 v[200:203], v[108:111], v[168:171], v[200:203]
  s_waitcnt vmcnt(5)
  v_mfma_f32_16x16x32_bf16 v[200:203], v[108:111], v[172:175], v[200:203]
  v_add_f32_dpp v204, v204, v204 quad_perm:[1,0,3,2] row_mask:0xf bank_mask:0xf
  v_add_f32_dpp v205, v205, v205 quad_perm:[1,0,3,2] row_mask:0xf bank_mask:0xf
  v_add_f32_dpp v206, v206, v206 quad_perm:[1,0,3,2] row_mask:0xf bank_mask:0xf
  v_add_f32_dpp v207, v207, v207 quad_perm:[1,0,3,2] row_mask:0xf bank_mask:0xf
  s_waitcnt vmcnt(4)
  v_mfma_f32_16x16x32_bf16 v[200:203], v[108:111], v[176:179], v[200:203]
  v_add_f32_dpp v204, v204, v204 quad_perm:[2,3,0,1] row_mask:0xf bank_mask:0xf
  v_add_f32_dpp v205, v205, v205 quad_perm:[2,3,0,1] row_mask:0xf bank_mask:0xf
  v_add_f32_dpp v206, v206, v206 quad_perm:[2,3,0,1] row_mask:0xf bank_mask:0xf
  v_add_f32_dpp v207, v207, v207 quad_perm:[2,3,0,1] row_mask:0xf bank_mask:0xf
  s_waitcnt vmcnt(3)
  v_mfma_f32_16x16x32_bf16 v[200:203], v[108:111], v[180:183], v[200:203]
  v_add_f32_dpp v204, v204, v204 row_half_mirror row_mask:0xf bank_mask:0xf
  v_add_f32_dpp v205, v205, v205 row_half_mirror row_mask:0xf bank_mask:0xf
  v_add_f32_dpp v206, v206, v206 row_half_mirror row_mask:0xf bank_mask:0xf
  v_add_f32_dpp v207, v207, v207 row_half_mirror row_mask:0xf bank_mask:0xf
  s_waitcnt vmcnt(2)
  v_mfma_f32_16x16x32_bf16 v[200:203], v[108:111], v[184:187], v[200:203]
  v_cvt_pk_bf16_f32 v204, v204, v205
  v_cvt_pk_bf16_f32 v205, v206, v207
  s_waitcnt vmcnt(1)
  v_mfma_f32_16x16x32_bf16 v[200:203], v[108:111], v[188:191], v[200:203]
  s_nop 7
  v_cvt_pk_bf16_f32 v200, v200, v201
  v_cvt_pk_bf16_f32 v201, v202, v203
  ds_write_b64 v90, v[200:201]
  ds_write_b64 v91, v[204:205]
  ds_write_b32 v96, v13 offset:4
  v_mul_f32 v128, v121, v248
  v_mul_f32 v129, v121, v249
  v_mul_f32 v130, v121, v250
  v_mul_f32 v131, v121, v251
  v_mul_f32 v132, v121, v252
  v_mul_f32 v133, v121, v253
  v_mul_f32 v134, v121, v254
  v_mul_f32 v135, v121, v255
  v_exp_f32 v128, v128 clamp
  v_exp_f32 v129, v129 clamp
  v_exp_f32 v130, v130 clamp
  v_exp_f32 v131, v131 clamp
  v_exp_f32 v132, v132 clamp
  v_exp_f32 v133, v133 clamp
  v_exp_f32 v134, v134 clamp
  v_exp_f32 v135, v135 clamp
  v_max_f32 v248, v123, v248
  v_max_f32 v249, v123, v249
  v_max_f32 v250, v123, v250
  v_max_f32 v251, v123, v251
  v_max_f32 v252, v123, v252
  v_max_f32 v253, v123, v253
  v_max_f32 v254, v123, v254
  v_max_f32 v255, v123, v255
  v_fmac_f32 v128, v248, v105
  v_fmac_f32 v129, v249, v105
  v_fmac_f32 v130, v250, v105
  v_fmac_f32 v131, v251, v105
  v_fmac_f32 v132, v252, v105
  v_fmac_f32 v133, v253, v105
  v_fmac_f32 v134, v254, v105
  v_fmac_f32 v135, v255, v105
  v_cvt_pk_bf16_f32 v248, v128, v129
  v_cvt_pk_bf16_f32 v249, v130, v131
  v_cvt_pk_bf16_f32 v250, v132, v133
  v_cvt_pk_bf16_f32 v251, v134, v135
  s_mov_b32 s84, 0
Lpw_28:
  ds_read_b32 v13, v12 offset:4
  ds_read_b128 v[136:139], v92
  ds_read_b128 v[140:143], v93
  s_add_u32 s84, s84, 1
  s_cmp_gt_u32 s84, 262144
  s_waitcnt lgkmcnt(0)
  s_cbranch_scc1 Lpwx_29
  v_cmp_eq_u32 vcc, 0, v13
  s_cbranch_vccnz Lpw_28
Lpwx_29:
  v_mfma_f32_32x32x16_bf16 v[160:175], v[136:139], v[224:227], 0
  v_mfma_f32_32x32x16_bf16 v[192:207], v[136:139], v[240:243], 0
  v_mfma_f32_32x32x16_bf16 v[176:191], v[140:143], v[232:235], 0
  v_mfma_f32_32x32x16_bf16 v[208:223], v[140:143], v[248:251], 0
  ds_read_b32 v159, v154
  s_waitcnt vmcnt(0)
  v_cmp_ne_u32 vcc, s73, v158
  s_cbranch_vccnz Lgc_30
Lgcok_31:
  buffer_load_dwordx4 v[16:19], v150, s[44:47], s70 offen offset:0 sc1
  buffer_load_dwordx4 v[20:23], v150, s[44:47], s70 offen offset:1024 sc1
  buffer_load_dwordx4 v[24:27], v150, s[44:47], s70 offen offset:2048 sc1
  buffer_load_dwordx4 v[28:31], v150, s[44:47], s70 offen offset:3072 sc1
  s_add_u32 s70, s70, 0x00001000
  buffer_load_dwordx4 v[32:35], v150, s[44:47], s70 offen offset:0 sc1
  buffer_load_dwordx4 v[36:39], v150, s[44:47], s70 offen offset:1024 sc1
  buffer_load_dwordx4 v[40:43], v150, s[44:47], s70 offen offset:2048 sc1
  buffer_load_dwordx4 v[44:47], v150, s[44:47], s70 offen offset:3072 sc1
  s_waitcnt lgkmcnt(0)
  v_cmp_gt_u32 vcc, 1, v159
  s_cbranch_vccnz Leb_34
Lebok_35:
  ds_read_b64_tr_b16 v[48:49], v144 offset:0
  ds_read_b64_tr_b16 v[50:51], v144 offset:1024
  ds_read_b64_tr_b16 v[52:53], v145 offset:0
  ds_read_b64_tr_b16 v[54:55], v145 offset:1024
  ds_read_b64_tr_b16 v[56:57], v144 offset:4096
  ds_read_b64_tr_b16 v[58:59], v144 offset:5120
  ds_read_b64_tr_b16 v[60:61], v145 offset:4096
  ds_read_b64_tr_b16 v[62:63], v145 offset:5120
  v_add_f32 v128, 0x358637bd, v168
  v_rcp_f32 v128, v128
  v_add_f32 v130, 0x358637bd, v200
  v_rcp_f32 v130, v130
  v_add_f32 v132, 0x358637bd, v184
  v_rcp_f32 v132, v132
  v_add_f32 v134, 0x358637bd, v216
  v_rcp_f32 v134, v134
  s_add_u32 s79, s4, 0
  v_pk_mul_f32 v[160:161], v[160:161], v[128:129] op_sel_hi:[1,0]
  v_pk_mul_f32 v[162:163], v[162:163], v[128:129] op_sel_hi:[1,0]
  v_pk_mul_f32 v[164:165], v[164:165], v[128:129] op_sel_hi:[1,0]
  v_pk_mul_f32 v[166:167], v[166:167], v[128:129] op_sel_hi:[1,0]
  v_cvt_pk_bf16_f32 v112, v160, v161
  v_cvt_pk_bf16_f32 v113, v162, v163
  v_cvt_pk_bf16_f32 v114, v164, v165
  v_cvt_pk_bf16_f32 v115, v166, v167
  buffer_store_dwordx4 v[112:115], v10, s[44:47], s79 offen sc1
  s_add_u32 s79, s4, 131072
  v_pk_mul_f32 v[192:193], v[192:193], v[130:131] op_sel_hi:[1,0]
  v_pk_mul_f32 v[194:195], v[194:195], v[130:131] op_sel_hi:[1,0]
  v_pk_mul_f32 v[196:197], v[196:197], v[130:131] op_sel_hi:[1,0]
  v_pk_mul_f32 v[198:199], v[198:199], v[130:131] op_sel_hi:[1,0]
  v_cvt_pk_bf16_f32 v116, v192, v193
  v_cvt_pk_bf16_f32 v117, v194, v195
  v_cvt_pk_bf16_f32 v118, v196, v197
  v_cvt_pk_bf16_f32 v119, v198, v199
  buffer_store_dwordx4 v[116:119], v10, s[44:47], s79 offen sc1
  s_add_u32 s79, s5, 0
  v_pk_mul_f32 v[176:177], v[176:177], v[132:133] op_sel_hi:[1,0]
  v_pk_mul_f32 v[178:179], v[178:179], v[132:133] op_sel_hi:[1,0]
  v_pk_mul_f32 v[180:181], v[180:181], v[132:133] op_sel_hi:[1,0]
  v_pk_mul_f32 v[182:183], v[182:183], v[132:133] op_sel_hi:[1,0]
  v_cvt_pk_bf16_f32 v112, v176, v177
  v_cvt_pk_bf16_f32 v113, v178, v179
  v_cvt_pk_bf16_f32 v114, v180, v181
  v_cvt_pk_bf16_f32 v115, v182, v183
  buffer_store_dwordx4 v[112:115], v10, s[44:47], s79 offen sc1
  s_add_u32 s79, s5, 131072
  v_pk_mul_f32 v[208:209], v[208:209], v[134:135] op_sel_hi:[1,0]
  v_pk_mul_f32 v[210:211], v[210:211], v[134:135] op_sel_hi:[1,0]
  v_pk_mul_f32 v[212:213], v[212:213], v[134:135] op_sel_hi:[1,0]
  v_pk_mul_f32 v[214:215], v[214:215], v[134:135] op_sel_hi:[1,0]
  v_cvt_pk_bf16_f32 v116, v208, v209
  v_cvt_pk_bf16_f32 v117, v210, v211
  v_cvt_pk_bf16_f32 v118, v212, v213
  v_cvt_pk_bf16_f32 v119, v214, v215
  buffer_store_dwordx4 v[116:119], v10, s[44:47], s79 offen sc1
  s_branch L_phase2
L_typeB:
  v_add_u32 v9, s81, v96
  buffer_load_ushort v108, v9, s[56:59], 0 offen
  v_add_u32 v9, s82, v96
  buffer_load_ushort v109, v9, s[56:59], 0 offen
  v_add_u32 v9, s83, v96
  buffer_load_ushort v110, v9, s[56:59], 0 offen
  s_lshl_b32 s4, s65, 1
  s_add_u32 s4, s4, s71
  s_lshl_b32 s4, s4, 18
  s_lshl_b32 s75, s66, 1
  s_add_u32 s75, s75, s72
  s_add_u32 s80, s75, 0
  s_lshl_b32 s80, s80, 10
  s_add_u32 s4, s4, s80
  s_lshl_b32 s5, s65, 1
  s_add_u32 s5, s5, s71
  s_lshl_b32 s5, s5, 18
  s_lshl_b32 s75, s66, 1
  s_add_u32 s75, s75, s72
  s_add_u32 s80, s75, 15
  s_lshl_b32 s80, s80, 10
  s_add_u32 s5, s5, s80
  s_lshl_b32 s6, s65, 1
  s_add_u32 s6, s6, s71
  s_lshl_b32 s6, s6, 18
  s_lshl_b32 s75, s66, 1
  s_add_u32 s75, s75, s72
  s_add_u32 s80, s75, 29
  s_lshl_b32 s80, s80, 10
  s_add_u32 s6, s6, s80
  s_lshl_b32 s76, s65, 1
  s_add_u32 s76, s76, s71
  s_mul_i32 s27, s76, 6144
  s_lshl_b32 s76, s75, 7
  s_add_u32 s27, s27, s76
  s_add_u32 s27, s27, 8912896
  s_mul_i32 s76, s66, 6
  s_add_u32 s76, s76, s72
  v_lshlrev_b32 v11, 4, v1
  s_cmp_lt_u32 s76, 43
  s_cselect_b32 s77, 0, 0x80000000
  v_or_b32 v12, s77, v11
  s_cmp_lt_u32 s76, 41
  s_cselect_b32 s77, 0, 0x80000000
  v_or_b32 v13, s77, v11
  s_cmp_lt_u32 s76, 39
  s_cselect_b32 s77, 0, 0x80000000
  v_or_b32 v14, s77, v11
  s_waitcnt vmcnt(4)
  buffer_load_dword v93, v126, s[48:51], 0 offen sc1
  v_lshlrev_b32 v136, 16, v128
  v_and_b32 v137, 0xffff0000, v128
  v_lshlrev_b32 v138, 16, v129
  v_and_b32 v139, 0xffff0000, v129
  v_lshlrev_b32 v140, 16, v130
  v_and_b32 v141, 0xffff0000, v130
  v_lshlrev_b32 v142, 16, v131
  v_and_b32 v143, 0xffff0000, v131
  v_lshlrev_b32 v144, 16, v132
  v_and_b32 v145, 0xffff0000, v132
  v_lshlrev_b32 v146, 16, v133
  v_and_b32 v147, 0xffff0000, v133
  v_lshlrev_b32 v148, 16, v134
  v_and_b32 v149, 0xffff0000, v134
  v_lshlrev_b32 v150, 16, v135
  v_and_b32 v151, 0xffff0000, v135
  v_add_f32 v128, v136, v137
  v_add_f32 v129, v138, v139
  v_add_f32 v130, v140, v141
  v_add_f32 v131, v142, v143
  v_add_f32 v132, v144, v145
  v_add_f32 v133, v146, v147
  v_add_f32 v134, v148, v149
  v_add_f32 v135, v150, v151
  v_add_f32 v128, v128, v132
  v_add_f32 v129, v129, v133
  v_add_f32 v130, v130, v134
  v_add_f32 v131, v131, v135
  v_add_f32 v128, v128, v130
  v_add_f32 v129, v129, v131
  v_add_f32 v128, v128, v129
  s_nop 1
  v_add_f32_dpp v128, v128, v128 quad_perm:[1,0,3,2] row_mask:0xf bank_mask:0xf
  s_nop 1
  v_add_f32_dpp v128, v128, v128 quad_perm:[2,3,0,1] row_mask:0xf bank_mask:0xf
  s_nop 1
  v_add_f32_dpp v128, v128, v128 row_half_mirror row_mask:0xf bank_mask:0xf
  s_nop 1
  v_add_f32_dpp v128, v128, v128 row_mirror row_mask:0xf bank_mask:0xf
  v_mov_b32 v129, v128
  s_nop 1
  v_permlane16_swap_b32 v128, v129
  v_add_f32 v128, v128, v129
  v_mul_f32 v90, 0x3b000000, v128
  v_sub_f32 v136, v136, v90
  v_sub_f32 v137, v137, v90
  v_sub_f32 v138, v138, v90
  v_sub_f32 v139, v139, v90
  v_sub_f32 v140, v140, v90
  v_sub_f32 v141, v141, v90
  v_sub_f32 v142, v142, v90
  v_sub_f32 v143, v143, v90
  v_sub_f32 v144, v144, v90
  v_sub_f32 v145, v145, v90
  v_sub_f32 v146, v146, v90
  v_sub_f32 v147, v147, v90
  v_sub_f32 v148, v148, v90
  v_sub_f32 v149, v149, v90
  v_sub_f32 v150, v150, v90
  v_sub_f32 v151, v151, v90
  v_mul_f32 v128, v136, v136
  v_mul_f32 v129, v137, v137
  v_mul_f32 v130, v138, v138
  v_mul_f32 v131, v139, v139
  v_fmac_f32 v128, v140, v140
  v_fmac_f32 v129, v141, v141
  v_fmac_f32 v130, v142, v142
  v_fmac_f32 v131, v143, v143
  v_fmac_f32 v128, v144, v144
  v_fmac_f32 v129, v145, v145
  v_fmac_f32 v130, v146, v146
  v_fmac_f32 v131, v147, v147
  v_fmac_f32 v128, v148, v148
  v_fmac_f32 v129, v149, v149
  v_fmac_f32 v130, v150, v150
  v_fmac_f32 v131, v151, v151
  v_add_f32 v128, v128, v129
  v_add_f32 v130, v130, v131
  v_add_f32 v128, v128, v130
  s_nop 1
  v_add_f32_dpp v128, v128, v128 quad_perm:[1,0,3,2] row_mask:0xf bank_mask:0xf
  s_nop 1
  v_add_f32_dpp v128, v128, v128 quad_perm:[2,3,0,1] row_mask:0xf bank_mask:0xf
  s_nop 1
  v_add_f32_dpp v128, v128, v128 row_half_mirror row_mask:0xf bank_mask:0xf
  s_nop 1
  v_add_f32_dpp v128, v128, v128 row_mirror row_mask:0xf bank_mask:0xf
  v_mov_b32 v129, v128
  s_nop 1
  v_permlane16_swap_b32 v128, v129
  v_add_f32 v128, v128, v129
  v_mov_b32 v129, 0x3727c5ac
  v_fmac_f32 v129, 0x3b000000, v128
  v_rsq_f32 v91, v129
  s_nop 0
  v_mul_f32 v92, v129, v91
  s_waitcnt lgkmcnt(0)
  s_barrier
  ds_read_b64_tr_b16 v[48:49], v84 offset:0
  ds_read_b64_tr_b16 v[50:51], v84 offset:512
  ds_read_b128 v[16:19], v76 offset:0
  ds_read_b64_tr_b16 v[52:53], v84 offset:4096
  ds_read_b64_tr_b16 v[54:55], v84 offset:4608
  ds_read_b128 v[20:23], v76 offset:4096
  s_waitcnt lgkmcnt(0)
  v_mfma_f32_32x32x16_bf16 v[160:175], v[48:51], v[16:19], 0
  ds_read_b64_tr_b16 v[56:57], v87 offset:2048
  ds_read_b64_tr_b16 v[58:59], v87 offset:2560
  ds_read_b128 v[24:27], v77 offset:0
  v_mfma_f32_32x32x16_bf16 v[176:191], v[48:51], v[20:23], 0
  ds_read_b64_tr_b16 v[60:61], v87 offset:6144
  ds_read_b64_tr_b16 v[62:63], v87 offset:6656
  ds_read_b128 v[28:31], v77 offset:4096
  v_mfma_f32_32x32x16_bf16 v[208:223], v[52:55], v[20:23], 0
  v_mfma_f32_16x16x32_bf16 v[68:71], v[64:67], v[48:51], 0
  v_mfma_f32_16x16x32_bf16 v[72:75], v[64:67], v[52:55], 0
  v_mfma_f32_32x32x16_bf16 v[192:207], v[52:55], v[16:19], 0
  s_waitcnt lgkmcnt(0)
  v_mfma_f32_32x32x16_bf16 v[160:175], v[56:59], v[24:27], v[160:175]
  s_barrier
  ds_read_b64_tr_b16 v[48:49], v85 offset:0
  ds_read_b64_tr_b16 v[50:51], v85 offset:512
  ds_read_b128 v[16:19], v78 offset:0
  v_mfma_f32_32x32x16_bf16 v[176:191], v[56:59], v[28:31], v[176:191]
  ds_read_b64_tr_b16 v[52:53], v85 offset:4096
  ds_read_b64_tr_b16 v[54:55], v85 offset:4608
  ds_read_b128 v[20:23], v78 offset:4096
  v_mfma_f32_32x32x16_bf16 v[208:223], v[60:63], v[28:31], v[208:223]
  v_mfma_f32_32x32x16_bf16 v[192:207], v[60:63], v[24:27], v[192:207]
  s_waitcnt lgkmcnt(0)
  v_mfma_f32_32x32x16_bf16 v[160:175], v[48:51], v[16:19], v[160:175]
  ds_read_b64_tr_b16 v[56:57], v88 offset:2048
  ds_read_b64_tr_b16 v[58:59], v88 offset:2560
  ds_read_b128 v[24:27], v79 offset:0
  s_waitcnt vmcnt(0)
  v_readfirstlane_b32 s73, v93
  s_nop 0
  s_cmp_eq_u32 s73, 0
  s_cbranch_scc1 Lnonce_37
Lnonceok_38:
  buffer_store_dwordx4 v[90:93], v124, s[44:47], 0 offen sc1
  v_mfma_f32_32x32x16_bf16 v[176:191], v[48:51], v[20:23], v[176:191]
  ds_read_b64_tr_b16 v[60:61], v88 offset:6144
  ds_read_b64_tr_b16 v[62:63], v88 offset:6656
  ds_read_b128 v[28:31], v79 offset:4096
  v_mov_b32 v8, 155648
  ds_write_b32 v8, v93
  v_lshlrev_b32 v108, 16, v108
  v_lshlrev_b32 v109, 16, v109
  v_mfma_f32_32x32x16_bf16 v[208:223], v[52:55], v[20:23], v[208:223]
  v_lshlrev_b32 v110, 16, v110
  s_mov_b32 s52, s20
  s_mov_b32 s53, s21
  s_mov_b32 s54, 2097152
  s_mov_b32 s55, 0x00020000
  v_mfma_f32_16x16x32_bf16 v[68:71], v[64:67], v[48:51], v[68:71]
  v_mfma_f32_16x16x32_bf16 v[72:75], v[64:67], v[52:55], v[72:75]
  v_mfma_f32_32x32x16_bf16 v[192:207], v[52:55], v[16:19], v[192:207]
  s_mov_b32 s60, s18
  s_mov_b32 s61, s19
  s_mov_b32 s62, 1024
  s_mov_b32 s63, 0x00020000
  s_waitcnt lgkmcnt(1)
  v_mfma_f32_32x32x16_bf16 v[160:175], v[56:59], v[24:27], v[160:175]
  s_waitcnt lgkmcnt(0)
  s_barrier
  ds_read_b64_tr_b16 v[48:49], v86 offset:0
  ds_read_b64_tr_b16 v[50:51], v86 offset:512
  ds_read_b128 v[16:19], v76 offset:16384
  s_lshl_b32 s12, s65, 1
  s_add_u32 s12, s12, s68
  s_lshl_b32 s13, s12, 2
  s_add_u32 s13, s13, s64
  s_lshl_b32 s70, s13, 16
  v_mfma_f32_32x32x16_bf16 v[176:191], v[56:59], v[28:31], v[176:191]
  ds_read_b64_tr_b16 v[52:53], v86 offset:4096
  ds_read_b64_tr_b16 v[54:55], v86 offset:4608
  ds_read_b128 v[20:23], v76 offset:20480
  v_lshlrev_b32 v150, 4, v1
  v_lshrrev_b32 v8, 2, v5
  v_mfma_f32_32x32x16_bf16 v[208:223], v[60:63], v[28:31], v[208:223]
  v_lshl_add_u32 v8, v3, 2, v8
  s_lshl_b32 s13, s72, 4
  v_add_u32 v8, s13, v8
  v_lshlrev_b32 v8, 7, v8
  v_and_b32 v9, 1, v5
  v_mfma_f32_32x32x16_bf16 v[192:207], v[60:63], v[24:27], v[192:207]
  v_lshl_add_u32 v8, v9, 3, v8
  v_and_b32 v9, 1, v4
  v_lshlrev_b32 v9, 1, v9
  v_bfe_u32 v0, v5, 1, 1
  v_add_u32 v9, v9, v0
  v_lshrrev_b32 v0, 3, v5
  s_waitcnt lgkmcnt(0)
  v_mfma_f32_32x32x16_bf16 v[160:175], v[48:51], v[16:19], v[160:175]
  ds_read_b64_tr_b16 v[56:57], v89 offset:2048
  ds_read_b64_tr_b16 v[58:59], v89 offset:2560
  ds_read_b128 v[24:27], v77 offset:16384
  v_lshlrev_b32 v0, 2, v0
  v_xor_b32 v9, v9, v0
  v_mfma_f32_32x32x16_bf16 v[176:191], v[48:51], v[20:23], v[176:191]
  ds_read_b64_tr_b16 v[60:61], v89 offset:6144
  ds_read_b64_tr_b16 v[62:63], v89 offset:6656
  ds_read_b128 v[28:31], v77 offset:20480
  s_lshl_b32 s13, s72, 2
  v_xor_b32 v9, s13, v9
  v_mfma_f32_32x32x16_bf16 v[208:223], v[52:55], v[20:23], v[208:223]
  v_lshl_add_u32 v144, v9, 4, v8
  v_xor_b32 v9, 4, v9
  v_lshl_add_u32 v145, v9, 4, v8
  v_add_u32 v146, 65536, v144
  v_add_u32 v147, 65536, v145
  v_add_u32 v148, 131072, v144
  v_mfma_f32_16x16x32_bf16 v[68:71], v[64:67], v[48:51], v[68:71]
  v_mfma_f32_16x16x32_bf16 v[72:75], v[64:67], v[52:55], v[72:75]
  v_mfma_f32_32x32x16_bf16 v[192:207], v[52:55], v[16:19], v[192:207]
  v_add_u32 v149, 131072, v145
  s_lshl_b32 s13, s64, 12
  s_add_u32 s13, s13, 86016
  v_add_u32 v151, s13, v150
  s_waitcnt lgkmcnt(0)
  v_mfma_f32_32x32x16_bf16 v[160:175], v[56:59], v[24:27], v[160:175]
  s_barrier
  ds_read_b64_tr_b16 v[48:49], v84 offset:0
  ds_read_b64_tr_b16 v[50:51], v84 offset:512
  ds_read_b128 v[16:19], v78 offset:16384
  s_xor_b32 s13, s64, 1
  s_lshl_b32 s13, s13, 12
  s_add_u32 s13, s13, 86016
  v_add_u32 v152, s13, v150
  v_mfma_f32_32x32x16_bf16 v[176:191], v[56:59], v[28:31], v[176:191]
  ds_read_b64_tr_b16 v[52:53], v84 offset:4096
  ds_read_b64_tr_b16 v[54:55], v84 offset:4608
  ds_read_b128 v[20:23], v78 offset:20480
  v_and_b32 v8, 3, v1
  v_lshlrev_b32 v8, 2, v8
  v_add_u32 v154, 155776, v8
  v_mfma_f32_32x32x16_bf16 v[208:223], v[60:63], v[28:31], v[208:223]
  v_lshlrev_b32 v0, 7, v5
  s_lshl_b32 s13, s64, 2
  s_add_u32 s13, s13, 155792
  v_mov_b32 v155, s13
  v_mfma_f32_32x32x16_bf16 v[192:207], v[60:63], v[24:27], v[192:207]
  s_lshl_b32 s13, s64, 4
  s_add_u32 s13, s13, 155712
  v_mov_b32 v157, s13
  s_xor_b32 s13, s13, 16
  v_mov_b32 v156, s13
  s_lshl_b32 s82, s12, 11
  s_add_u32 s82, s82, 9109504
  s_waitcnt lgkmcnt(0)
  v_mfma_f32_32x32x16_bf16 v[160:175], v[48:51], v[16:19], v[160:175]
  ds_read_b64_tr_b16 v[56:57], v87 offset:2048
  ds_read_b64_tr_b16 v[58:59], v87 offset:2560
  ds_read_b128 v[24:27], v79 offset:16384
  s_mov_b32 s14, s69
  v_mfma_f32_32x32x16_bf16 v[176:191], v[48:51], v[20:23], v[176:191]
  ds_read_b64_tr_b16 v[60:61], v87 offset:6144
  ds_read_b64_tr_b16 v[62:63], v87 offset:6656
  ds_read_b128 v[28:31], v79 offset:20480
  s_lshr_b32 s13, s2, 6
  s_mul_i32 s13, s13, 1
  s_add_u32 s13, s13, s69
  v_mfma_f32_32x32x16_bf16 v[208:223], v[52:55], v[20:23], v[208:223]
  s_mul_i32 s15, s13, 128
  s_lshr_b32 s15, s15, 8
  s_mul_i32 s15, s15, 2
  s_sub_u32 s13, s13, s15
  s_sub_u32 s13, s69, s13
  s_add_u32 s15, s13, 2
  s_cmp_lt_i32 s13, 1
  s_cselect_b32 s13, s15, s13
  v_mfma_f32_16x16x32_bf16 v[68:71], v[64:67], v[48:51], v[68:71]
  v_mfma_f32_16x16x32_bf16 v[72:75], v[64:67], v[52:55], v[72:75]
  v_mfma_f32_32x32x16_bf16 v[192:207], v[52:55], v[16:19], v[192:207]
  s_sub_u32 s15, s69, 1
  s_cmp_lt_u32 s15, 2
  s_cselect_b32 s14, s13, s14
  s_waitcnt lgkmcnt(0)
  v_mfma_f32_32x32x16_bf16 v[160:175], v[56:59], v[24:27], v[160:175]
  s_barrier
  ds_read_b64_tr_b16 v[48:49], v85 offset:0
  ds_read_b64_tr_b16 v[50:51], v85 offset:512
  ds_read_b128 v[16:19], v76 offset:32768
  s_lshr_b32 s13, s2, 6
  s_mul_i32 s13, s13, 1
  s_add_u32 s13, s13, s69
  v_mfma_f32_32x32x16_bf16 v[176:191], v[56:59], v[28:31], v[176:191]
  ds_read_b64_tr_b16 v[52:53], v85 offset:4096
  ds_read_b64_tr_b16 v[54:55], v85 offset:4608
  ds_read_b128 v[20:23], v76 offset:36864
  s_mul_i32 s15, s13, 128
  s_lshr_b32 s15, s15, 8
  s_mul_i32 s15, s15, 2
  s_sub_u32 s13, s13, s15
  v_mfma_f32_32x32x16_bf16 v[208:223], v[60:63], v[28:31], v[208:223]
  s_sub_u32 s13, s69, s13
  s_add_u32 s15, s13, 2
  s_cmp_lt_i32 s13, 3
  s_cselect_b32 s13, s15, s13
  v_mfma_f32_32x32x16_bf16 v[192:207], v[60:63], v[24:27], v[192:207]
  s_sub_u32 s15, s69, 3
  s_cmp_lt_u32 s15, 2
  s_cselect_b32 s14, s13, s14
  s_lshr_b32 s13, s2, 6
  s_mul_i32 s13, s13, 1
  s_add_u32 s13, s13, s69
  s_waitcnt lgkmcnt(0)
  v_mfma_f32_32x32x16_bf16 v[160:175], v[48:51], v[16:19], v[160:175]
  ds_read_b64_tr_b16 v[56:57], v88 offset:2048
  ds_read_b64_tr_b16 v[58:59], v88 offset:2560
  ds_read_b128 v[24:27], v77 offset:32768
  s_mul_i32 s15, s13, 86
  s_lshr_b32 s15, s15, 8
  s_mul_i32 s15, s15, 3
  s_sub_u32 s13, s13, s15
  v_mfma_f32_32x32x16_bf16 v[176:191], v[48:51], v[20:23], v[176:191]
  ds_read_b64_tr_b16 v[60:61], v88 offset:6144
  ds_read_b64_tr_b16 v[62:63], v88 offset:6656
  ds_read_b128 v[28:31], v77 offset:36864
  v_mfma_f32_32x32x16_bf16 v[208:223], v[52:55], v[20:23], v[208:223]
  s_sub_u32 s13, s69, s13
  s_add_u32 s15, s13, 3
  s_cmp_lt_i32 s13, 5
  s_cselect_b32 s13, s15, s13
  s_sub_u32 s15, s69, 5
  s_cmp_lt_u32 s15, 3
  s_cselect_b32 s14, s13, s14
  v_mfma_f32_16x16x32_bf16 v[68:71], v[64:67], v[48:51], v[68:71]
  v_mfma_f32_16x16x32_bf16 v[72:75], v[64:67], v[52:55], v[72:75]
  v_mfma_f32_32x32x16_bf16 v[192:207], v[52:55], v[16:19], v[192:207]
  s_lshl_b32 s14, s14, 2
  s_lshl_b32 s13, s68, 1
  s_add_u32 s14, s14, s13
  s_add_u32 s14, s14, s71
  s_lshl_b32 s14, s14, 12
  v_bfe_u32 v8, v1, 1, 3
  s_waitcnt lgkmcnt(0)
  v_mfma_f32_32x32x16_bf16 v[160:175], v[56:59], v[24:27], v[160:175]
  s_barrier
  ds_read_b64_tr_b16 v[48:49], v86 offset:0
  ds_read_b64_tr_b16 v[50:51], v86 offset:512
  ds_read_b128 v[16:19], v78 offset:32768
  s_lshl_b32 s13, s72, 2
  v_xor_b32 v8, s13, v8
  v_mfma_f32_32x32x16_bf16 v[176:191], v[56:59], v[28:31], v[176:191]
  ds_read_b64_tr_b16 v[52:53], v86 offset:4096
  ds_read_b64_tr_b16 v[54:55], v86 offset:4608
  ds_read_b128 v[20:23], v78 offset:36864
  v_lshlrev_b32 v8, 4, v8
  v_lshl_add_u32 v8, v3, 3, v8
  v_mfma_f32_32x32x16_bf16 v[208:223], v[60:63], v[28:31], v[208:223]
  v_lshl_add_u32 v8, v2, 7, v8
  v_add_u32 v124, s14, v8
  s_lshl_b32 s12, s12, 1
  s_add_u32 s12, s12, s71
  s_lshl_b32 s12, s12, 15
  v_mfma_f32_32x32x16_bf16 v[192:207], v[60:63], v[24:27], v[192:207]
  s_lshl_b32 s13, s69, 1
  s_add_u32 s13, s13, s72
  s_lshl_b32 s13, s13, 6
  s_add_u32 s12, s12, s13
  v_lshl_add_u32 v8, v2, 10, s12
  v_lshl_add_u32 v153, v3, 4, v8
  s_mov_b32 s83, s13
  s_waitcnt lgkmcnt(0)
  v_mfma_f32_32x32x16_bf16 v[160:175], v[48:51], v[16:19], v[160:175]
  ds_read_b64_tr_b16 v[56:57], v89 offset:2048
  ds_read_b64_tr_b16 v[58:59], v89 offset:2560
  ds_read_b128 v[24:27], v79 offset:32768
  buffer_load_dword v127, v98, s[32:35], 0 offen
  v_mfma_f32_32x32x16_bf16 v[176:191], v[48:51], v[20:23], v[176:191]
  ds_read_b64_tr_b16 v[60:61], v89 offset:6144
  ds_read_b64_tr_b16 v[62:63], v89 offset:6656
  ds_read_b128 v[28:31], v79 offset:36864
  v_mfma_f32_32x32x16_bf16 v[208:223], v[52:55], v[20:23], v[208:223]
  v_mfma_f32_16x16x32_bf16 v[68:71], v[64:67], v[48:51], v[68:71]
  v_mfma_f32_16x16x32_bf16 v[72:75], v[64:67], v[52:55], v[72:75]
  v_mfma_f32_32x32x16_bf16 v[192:207], v[52:55], v[16:19], v[192:207]
  s_waitcnt lgkmcnt(0)
  v_mfma_f32_32x32x16_bf16 v[160:175], v[56:59], v[24:27], v[160:175]
  s_barrier
  ds_read_b64_tr_b16 v[48:49], v84 offset:0
  ds_read_b64_tr_b16 v[50:51], v84 offset:512
  ds_read_b128 v[16:19], v76 offset:49152
  v_mfma_f32_32x32x16_bf16 v[176:191], v[56:59], v[28:31], v[176:191]
  ds_read_b64_tr_b16 v[52:53], v84 offset:4096
  ds_read_b64_tr_b16 v[54:55], v84 offset:4608
  ds_read_b128 v[20:23], v76 offset:53248
  v_mfma_f32_32x32x16_bf16 v[208:223], v[60:63], v[28:31], v[208:223]
  v_mfma_f32_32x32x16_bf16 v[192:207], v[60:63], v[24:27], v[192:207]
  s_waitcnt lgkmcnt(0)
  v_mfma_f32_32x32x16_bf16 v[160:175], v[48:51], v[16:19], v[160:175]
  ds_read_b64_tr_b16 v[56:57], v87 offset:2048
  ds_read_b64_tr_b16 v[58:59], v87 offset:2560
  ds_read_b128 v[24:27], v77 offset:49152
  v_mfma_f32_32x32x16_bf16 v[176:191], v[48:51], v[20:23], v[176:191]
  ds_read_b64_tr_b16 v[60:61], v87 offset:6144
  ds_read_b64_tr_b16 v[62:63], v87 offset:6656
  ds_read_b128 v[28:31], v77 offset:53248
  v_mfma_f32_32x32x16_bf16 v[208:223], v[52:55], v[20:23], v[208:223]
  v_mfma_f32_16x16x32_bf16 v[68:71], v[64:67], v[48:51], v[68:71]
  v_mfma_f32_16x16x32_bf16 v[72:75], v[64:67], v[52:55], v[72:75]
  v_mfma_f32_32x32x16_bf16 v[192:207], v[52:55], v[16:19], v[192:207]
  s_waitcnt lgkmcnt(0)
  v_mfma_f32_32x32x16_bf16 v[160:175], v[56:59], v[24:27], v[160:175]
  s_barrier
  ds_read_b64_tr_b16 v[48:49], v85 offset:0
  ds_read_b64_tr_b16 v[50:51], v85 offset:512
  ds_read_b128 v[16:19], v78 offset:49152
  v_mfma_f32_32x32x16_bf16 v[176:191], v[56:59], v[28:31], v[176:191]
  ds_read_b64_tr_b16 v[52:53], v85 offset:4096
  ds_read_b64_tr_b16 v[54:55], v85 offset:4608
  ds_read_b128 v[20:23], v78 offset:53248
  v_mfma_f32_32x32x16_bf16 v[208:223], v[60:63], v[28:31], v[208:223]
  v_mfma_f32_32x32x16_bf16 v[192:207], v[60:63], v[24:27], v[192:207]
  s_waitcnt lgkmcnt(0)
  v_mfma_f32_32x32x16_bf16 v[160:175], v[48:51], v[16:19], v[160:175]
  ds_read_b64_tr_b16 v[56:57], v88 offset:2048
  ds_read_b64_tr_b16 v[58:59], v88 offset:2560
  ds_read_b128 v[24:27], v79 offset:49152
  buffer_load_dword v127, v99, s[32:35], 0 offen
  v_mfma_f32_32x32x16_bf16 v[176:191], v[48:51], v[20:23], v[176:191]
  ds_read_b64_tr_b16 v[60:61], v88 offset:6144
  ds_read_b64_tr_b16 v[62:63], v88 offset:6656
  ds_read_b128 v[28:31], v79 offset:53248
  v_mfma_f32_32x32x16_bf16 v[208:223], v[52:55], v[20:23], v[208:223]
  v_mfma_f32_16x16x32_bf16 v[68:71], v[64:67], v[48:51], v[68:71]
  v_mfma_f32_16x16x32_bf16 v[72:75], v[64:67], v[52:55], v[72:75]
  v_mfma_f32_32x32x16_bf16 v[192:207], v[52:55], v[16:19], v[192:207]
  s_waitcnt lgkmcnt(0)
  v_mfma_f32_32x32x16_bf16 v[160:175], v[56:59], v[24:27], v[160:175]
  s_barrier
  ds_read_b64_tr_b16 v[48:49], v86 offset:0
  ds_read_b64_tr_b16 v[50:51], v86 offset:512
  ds_read_b128 v[16:19], v80 offset:0
  v_mfma_f32_32x32x16_bf16 v[176:191], v[56:59], v[28:31], v[176:191]
  ds_read_b64_tr_b16 v[52:53], v86 offset:4096
  ds_read_b64_tr_b16 v[54:55], v86 offset:4608
  ds_read_b128 v[20:23], v80 offset:4096
  v_mfma_f32_32x32x16_bf16 v[208:223], v[60:63], v[28:31], v[208:223]
  v_mfma_f32_32x32x16_bf16 v[192:207], v[60:63], v[24:27], v[192:207]
  s_waitcnt lgkmcnt(0)
  v_mfma_f32_32x32x16_bf16 v[160:175], v[48:51], v[16:19], v[160:175]
  ds_read_b64_tr_b16 v[56:57], v89 offset:2048
  ds_read_b64_tr_b16 v[58:59], v89 offset:2560
  ds_read_b128 v[24:27], v81 offset:0
  v_mfma_f32_32x32x16_bf16 v[176:191], v[48:51], v[20:23], v[176:191]
  ds_read_b64_tr_b16 v[60:61], v89 offset:6144
  ds_read_b64_tr_b16 v[62:63], v89 offset:6656
  ds_read_b128 v[28:31], v81 offset:4096
  v_mfma_f32_32x32x16_bf16 v[208:223], v[52:55], v[20:23], v[208:223]
  v_mfma_f32_16x16x32_bf16 v[68:71], v[64:67], v[48:51], v[68:71]
  v_mfma_f32_16x16x32_bf16 v[72:75], v[64:67], v[52:55], v[72:75]
  v_mfma_f32_32x32x16_bf16 v[192:207], v[52:55], v[16:19], v[192:207]
  s_waitcnt lgkmcnt(0)
  v_mfma_f32_32x32x16_bf16 v[160:175], v[56:59], v[24:27], v[160:175]
  s_barrier
  ds_read_b64_tr_b16 v[48:49], v84 offset:0
  ds_read_b64_tr_b16 v[50:51], v84 offset:512
  ds_read_b128 v[16:19], v82 offset:0
  v_mfma_f32_32x32x16_bf16 v[176:191], v[56:59], v[28:31], v[176:191]
  ds_read_b64_tr_b16 v[52:53], v84 offset:4096
  ds_read_b64_tr_b16 v[54:55], v84 offset:4608
  ds_read_b128 v[20:23], v82 offset:4096
  v_mfma_f32_32x32x16_bf16 v[208:223], v[60:63], v[28:31], v[208:223]
  v_mfma_f32_32x32x16_bf16 v[192:207], v[60:63], v[24:27], v[192:207]
  s_waitcnt lgkmcnt(0)
  v_mfma_f32_32x32x16_bf16 v[160:175], v[48:51], v[16:19], v[160:175]
  ds_read_b64_tr_b16 v[56:57], v87 offset:2048
  ds_read_b64_tr_b16 v[58:59], v87 offset:2560
  ds_read_b128 v[24:27], v83 offset:0
  v_mfma_f32_32x32x16_bf16 v[176:191], v[48:51], v[20:23], v[176:191]
  ds_read_b64_tr_b16 v[60:61], v87 offset:6144
  ds_read_b64_tr_b16 v[62:63], v87 offset:6656
  ds_read_b128 v[28:31], v83 offset:4096
  v_mfma_f32_32x32x16_bf16 v[208:223], v[52:55], v[20:23], v[208:223]
  v_mfma_f32_16x16x32_bf16 v[68:71], v[64:67], v[48:51], v[68:71]
  v_mfma_f32_16x16x32_bf16 v[72:75], v[64:67], v[52:55], v[72:75]
  v_mfma_f32_32x32x16_bf16 v[192:207], v[52:55], v[16:19], v[192:207]
  s_waitcnt lgkmcnt(0)
  v_mfma_f32_32x32x16_bf16 v[160:175], v[56:59], v[24:27], v[160:175]
  s_barrier
  ds_read_b64_tr_b16 v[48:49], v85 offset:0
  ds_read_b64_tr_b16 v[50:51], v85 offset:512
  ds_read_b128 v[16:19], v80 offset:16384
  v_mfma_f32_32x32x16_bf16 v[176:191], v[56:59], v[28:31], v[176:191]
  ds_read_b64_tr_b16 v[52:53], v85 offset:4096
  ds_read_b64_tr_b16 v[54:55], v85 offset:4608
  ds_read_b128 v[20:23], v80 offset:20480
  v_mfma_f32_32x32x16_bf16 v[208:223], v[60:63], v[28:31], v[208:223]
  v_mfma_f32_32x32x16_bf16 v[192:207], v[60:63], v[24:27], v[192:207]
  s_waitcnt lgkmcnt(0)
  v_mfma_f32_32x32x16_bf16 v[160:175], v[48:51], v[16:19], v[160:175]
  ds_read_b64_tr_b16 v[56:57], v88 offset:2048
  ds_read_b64_tr_b16 v[58:59], v88 offset:2560
  ds_read_b128 v[24:27], v81 offset:16384
  buffer_load_dwordx4 v[100:103], v125, s[44:47], 0 offen offset:0 sc1
  buffer_load_dwordx4 v[104:107], v125, s[44:47], 0 offen offset:1024 sc1
  v_mfma_f32_32x32x16_bf16 v[176:191], v[48:51], v[20:23], v[176:191]
  ds_read_b64_tr_b16 v[60:61], v88 offset:6144
  ds_read_b64_tr_b16 v[62:63], v88 offset:6656
  ds_read_b128 v[28:31], v81 offset:20480
  v_mfma_f32_32x32x16_bf16 v[208:223], v[52:55], v[20:23], v[208:223]
  v_mfma_f32_16x16x32_bf16 v[68:71], v[64:67], v[48:51], v[68:71]
  v_mfma_f32_16x16x32_bf16 v[72:75], v[64:67], v[52:55], v[72:75]
  v_mfma_f32_32x32x16_bf16 v[192:207], v[52:55], v[16:19], v[192:207]
  s_waitcnt lgkmcnt(0)
  v_mfma_f32_32x32x16_bf16 v[160:175], v[56:59], v[24:27], v[160:175]
  s_barrier
  ds_read_b64_tr_b16 v[48:49], v86 offset:0
  ds_read_b64_tr_b16 v[50:51], v86 offset:512
  ds_read_b128 v[16:19], v82 offset:16384
  v_mfma_f32_32x32x16_bf16 v[176:191], v[56:59], v[28:31], v[176:191]
  ds_read_b64_tr_b16 v[52:53], v86 offset:4096
  ds_read_b64_tr_b16 v[54:55], v86 offset:4608
  ds_read_b128 v[20:23], v82 offset:20480
  v_mfma_f32_32x32x16_bf16 v[208:223], v[60:63], v[28:31], v[208:223]
  v_mfma_f32_32x32x16_bf16 v[192:207], v[60:63], v[24:27], v[192:207]
  s_waitcnt lgkmcnt(0)
  v_mfma_f32_32x32x16_bf16 v[160:175], v[48:51], v[16:19], v[160:175]
  ds_read_b64_tr_b16 v[56:57], v89 offset:2048
  ds_read_b64_tr_b16 v[58:59], v89 offset:2560
  ds_read_b128 v[24:27], v83 offset:16384
  v_mfma_f32_32x32x16_bf16 v[176:191], v[48:51], v[20:23], v[176:191]
  ds_read_b64_tr_b16 v[60:61], v89 offset:6144
  ds_read_b64_tr_b16 v[62:63], v89 offset:6656
  ds_read_b128 v[28:31], v83 offset:20480
  v_mfma_f32_32x32x16_bf16 v[208:223], v[52:55], v[20:23], v[208:223]
  v_mfma_f32_16x16x32_bf16 v[68:71], v[64:67], v[48:51], v[68:71]
  v_mfma_f32_16x16x32_bf16 v[72:75], v[64:67], v[52:55], v[72:75]
  v_mfma_f32_32x32x16_bf16 v[192:207], v[52:55], v[16:19], v[192:207]
  s_waitcnt lgkmcnt(0)
  v_mfma_f32_32x32x16_bf16 v[160:175], v[56:59], v[24:27], v[160:175]
  s_barrier
  ds_read_b64_tr_b16 v[48:49], v84 offset:0
  ds_read_b64_tr_b16 v[50:51], v84 offset:512
  ds_read_b128 v[16:19], v80 offset:32768
  v_mfma_f32_32x32x16_bf16 v[176:191], v[56:59], v[28:31], v[176:191]
  ds_read_b64_tr_b16 v[52:53], v84 offset:4096
  ds_read_b64_tr_b16 v[54:55], v84 offset:4608
  ds_read_b128 v[20:23], v80 offset:36864
  v_mfma_f32_32x32x16_bf16 v[208:223], v[60:63], v[28:31], v[208:223]
  v_mfma_f32_32x32x16_bf16 v[192:207], v[60:63], v[24:27], v[192:207]
  s_waitcnt lgkmcnt(0)
  v_mfma_f32_32x32x16_bf16 v[160:175], v[48:51], v[16:19], v[160:175]
  ds_read_b64_tr_b16 v[56:57], v87 offset:2048
  ds_read_b64_tr_b16 v[58:59], v87 offset:2560
  ds_read_b128 v[24:27], v81 offset:32768
  v_mfma_f32_32x32x16_bf16 v[176:191], v[48:51], v[20:23], v[176:191]
  ds_read_b64_tr_b16 v[60:61], v87 offset:6144
  ds_read_b64_tr_b16 v[62:63], v87 offset:6656
  ds_read_b128 v[28:31], v81 offset:36864
  v_mfma_f32_32x32x16_bf16 v[208:223], v[52:55], v[20:23], v[208:223]
  v_mfma_f32_16x16x32_bf16 v[68:71], v[64:67], v[48:51], v[68:71]
  v_mfma_f32_16x16x32_bf16 v[72:75], v[64:67], v[52:55], v[72:75]
  v_mfma_f32_32x32x16_bf16 v[192:207], v[52:55], v[16:19], v[192:207]
  s_waitcnt lgkmcnt(0)
  v_mfma_f32_32x32x16_bf16 v[160:175], v[56:59], v[24:27], v[160:175]
  s_barrier
  ds_read_b64_tr_b16 v[48:49], v85 offset:0
  ds_read_b64_tr_b16 v[50:51], v85 offset:512
  ds_read_b128 v[16:19], v82 offset:32768
  v_mfma_f32_32x32x16_bf16 v[176:191], v[56:59], v[28:31], v[176:191]
  ds_read_b64_tr_b16 v[52:53], v85 offset:4096
  ds_read_b64_tr_b16 v[54:55], v85 offset:4608
  ds_read_b128 v[20:23], v82 offset:36864
  v_mfma_f32_32x32x16_bf16 v[208:223], v[60:63], v[28:31], v[208:223]
  v_mfma_f32_32x32x16_bf16 v[192:207], v[60:63], v[24:27], v[192:207]
  s_waitcnt lgkmcnt(0)
  v_mfma_f32_32x32x16_bf16 v[160:175], v[48:51], v[16:19], v[160:175]
  ds_read_b64_tr_b16 v[56:57], v88 offset:2048
  ds_read_b64_tr_b16 v[58:59], v88 offset:2560
  ds_read_b128 v[24:27], v83 offset:32768
  s_waitcnt vmcnt(0)
  v_cmp_ne_u32 vcc, s73, v103
  v_cmp_ne_u32 s[86:87], s73, v107
  s_nop 0
  s_or_b64 vcc, vcc, s[86:87]
  s_cbranch_vccnz Lst_40
Lstok_41:
  v_cvt_pk_bf16_f32 v128, -v100, -v100
  v_cvt_pk_bf16_f32 v129, v102, v102
  v_mfma_f32_32x32x16_bf16 v[176:191], v[48:51], v[20:23], v[176:191]
  ds_read_b64_tr_b16 v[60:61], v88 offset:6144
  ds_read_b64_tr_b16 v[62:63], v88 offset:6656
  ds_read_b128 v[28:31], v83 offset:36864
  v_and_b32 v130, 0xffff0000, v128
  v_mfma_f32_32x32x16_bf16 v[208:223], v[52:55], v[20:23], v[208:223]
  v_and_b32 v131, 0xffff0000, v129
  v_sub_f32 v130, -v100, v130
  v_sub_f32 v132, v102, v131
  v_cvt_pk_bf16_f32 v130, v130, v131
  v_cvt_pk_bf16_f32 v132, v132, 0
  v_mfma_f32_16x16x32_bf16 v[68:71], v[64:67], v[48:51], v[68:71]
  v_mfma_f32_16x16x32_bf16 v[72:75], v[64:67], v[52:55], v[72:75]
  v_mfma_f32_32x32x16_bf16 v[192:207], v[52:55], v[16:19], v[192:207]
  v_cmp_gt_u32 vcc, 32, v1
  v_mov_b32 v115, 0
  s_nop 0
  v_cndmask_b32 v112, 0, v128, vcc
  v_cndmask_b32 v113, 0, v130, vcc
  v_cndmask_b32 v114, 0, v132, vcc
  v_cvt_pk_bf16_f32 v128, -v104, -v104
  s_waitcnt lgkmcnt(0)
  v_mfma_f32_32x32x16_bf16 v[160:175], v[56:59], v[24:27], v[160:175]
  s_barrier
  ds_read_b64_tr_b16 v[48:49], v86 offset:0
  ds_read_b64_tr_b16 v[50:51], v86 offset:512
  ds_read_b128 v[16:19], v80 offset:49152
  v_cvt_pk_bf16_f32 v129, v106, v106
  v_and_b32 v130, 0xffff0000, v128
  v_mfma_f32_32x32x16_bf16 v[176:191], v[56:59], v[28:31], v[176:191]
  ds_read_b64_tr_b16 v[52:53], v86 offset:4096
  ds_read_b64_tr_b16 v[54:55], v86 offset:4608
  ds_read_b128 v[20:23], v80 offset:53248
  v_and_b32 v131, 0xffff0000, v129
  v_sub_f32 v130, -v104, v130
  v_mfma_f32_32x32x16_bf16 v[208:223], v[60:63], v[28:31], v[208:223]
  v_sub_f32 v132, v106, v131
  v_cvt_pk_bf16_f32 v130, v130, v131
  v_cvt_pk_bf16_f32 v132, v132, 0
  v_mfma_f32_32x32x16_bf16 v[192:207], v[60:63], v[24:27], v[192:207]
  v_cmp_gt_u32 vcc, 32, v1
  v_mov_b32 v119, 0
  s_nop 0
  v_cndmask_b32 v116, 0, v128, vcc
  v_cndmask_b32 v117, 0, v130, vcc
  v_cndmask_b32 v118, 0, v132, vcc
  v_mul_f32 v120, 0xc0135761, v101
  s_waitcnt lgkmcnt(0)
  v_mfma_f32_32x32x16_bf16 v[160:175], v[48:51], v[16:19], v[160:175]
  ds_read_b64_tr_b16 v[56:57], v89 offset:2048
  ds_read_b64_tr_b16 v[58:59], v89 offset:2560
  ds_read_b128 v[24:27], v81 offset:49152
  v_mul_f32 v128, v101, v101
  v_mul_f32 v128, 0x3d372713, v128
  v_mfma_f32_32x32x16_bf16 v[176:191], v[48:51], v[20:23], v[176:191]
  ds_read_b64_tr_b16 v[60:61], v89 offset:6144
  ds_read_b64_tr_b16 v[62:63], v89 offset:6656
  ds_read_b128 v[28:31], v81 offset:53248
  v_mul_f32 v122, v128, v120
  v_mul_f32 v121, 0xc0135761, v105
  v_mfma_f32_32x32x16_bf16 v[208:223], v[52:55], v[20:23], v[208:223]
  v_mul_f32 v128, v105, v105
  v_mul_f32 v128, 0x3d372713, v128
  v_mul_f32 v123, v128, v121
  v_mfma_f32_16x16x32_bf16 v[68:71], v[64:67], v[48:51], v[68:71]
  v_mfma_f32_16x16x32_bf16 v[72:75], v[64:67], v[52:55], v[72:75]
  v_mfma_f32_32x32x16_bf16 v[192:207], v[52:55], v[16:19], v[192:207]
  s_waitcnt lgkmcnt(0)
  v_mfma_f32_32x32x16_bf16 v[160:175], v[56:59], v[24:27], v[160:175]
  s_barrier
  ds_read_b64_tr_b16 v[48:49], v84 offset:0
  ds_read_b64_tr_b16 v[50:51], v84 offset:512
  ds_read_b128 v[16:19], v82 offset:49152
  v_mfma_f32_32x32x16_bf16 v[176:191], v[56:59], v[28:31], v[176:191]
  ds_read_b64_tr_b16 v[52:53], v84 offset:4096
  ds_read_b64_tr_b16 v[54:55], v84 offset:4608
  ds_read_b128 v[20:23], v82 offset:53248
  v_mfma_f32_32x32x16_bf16 v[208:223], v[60:63], v[28:31], v[208:223]
  v_mfma_f32_32x32x16_bf16 v[192:207], v[60:63], v[24:27], v[192:207]
  s_waitcnt lgkmcnt(0)
  v_mfma_f32_32x32x16_bf16 v[160:175], v[48:51], v[16:19], v[160:175]
  ds_read_b64_tr_b16 v[56:57], v87 offset:2048
  ds_read_b64_tr_b16 v[58:59], v87 offset:2560
  ds_read_b128 v[24:27], v83 offset:49152
  v_mfma_f32_16x16x32_bf16 v[68:71], v[64:67], v[48:51], v[68:71]
  v_mfma_f32_16x16x32_bf16 v[72:75], v[64:67], v[52:55], v[72:75]
  v_mfma_f32_32x32x16_bf16 v[176:191], v[48:51], v[20:23], v[176:191]
  ds_read_b64_tr_b16 v[60:61], v87 offset:6144
  ds_read_b64_tr_b16 v[62:63], v87 offset:6656
  ds_read_b128 v[28:31], v83 offset:53248
  v_mfma_f32_32x32x16_bf16 v[208:223], v[52:55], v[20:23], v[208:223]
  s_nop 1
  ds_write_b32 v94, v68 offset:0
  ds_write_b32 v94, v72 offset:128
  v_mfma_f32_32x32x16_bf16 v[192:207], v[52:55], v[16:19], v[192:207]
  s_waitcnt lgkmcnt(2)
  v_mfma_f32_32x32x16_bf16 v[160:175], v[56:59], v[24:27], v[160:175]
  s_waitcnt lgkmcnt(0)
  s_barrier
  ds_read_b32 v69, v95 offset:0
  ds_read_b32 v73, v95 offset:128
  ds_read_b64_tr_b16 v[48:49], v85 offset:0
  ds_read_b64_tr_b16 v[50:51], v85 offset:512
  ds_read_b128 v[16:19], v76 offset:0
  v_mfma_f32_32x32x16_bf16 v[176:191], v[56:59], v[28:31], v[176:191]
  ds_read_b64_tr_b16 v[52:53], v88 offset:2048
  ds_read_b64_tr_b16 v[54:55], v88 offset:2560
  ds_read_b128 v[20:23], v76 offset:4096
  v_mfma_f32_32x32x16_bf16 v[192:207], v[60:63], v[24:27], v[192:207]
  ds_read_b128 v[24:27], v77 offset:0
  v_mfma_f32_32x32x16_bf16 v[208:223], v[60:63], v[28:31], v[208:223]
  ds_read_b128 v[28:31], v77 offset:4096
  s_waitcnt lgkmcnt(8)
  s_waitcnt lgkmcnt(2)
  v_mfma_f32_32x32x16_bf16 v[224:239], v[48:51], v[16:19], 0
  ds_read_b64_tr_b16 v[56:57], v85 offset:4096
  ds_read_b64_tr_b16 v[58:59], v85 offset:4608
  ds_read_b128 v[32:35], v78 offset:0
  v_add_f32 v68, v68, v69
  v_cvt_pk_bf16_f32 v69, v68, v68
  v_and_b32 v69, 0xffff0000, v69
  v_sub_f32 v70, v68, v69
  v_mov_b32 v139, 0
  v_cvt_pk_bf16_f32 v137, v69, v108
  v_cvt_pk_bf16_f32 v138, v108, 0
  v_cvt_pk_bf16_f32 v136, v69, v70
  s_nop 1
  v_mfma_f32_32x32x16_bf16 v[160:175], v[136:139], v[112:115], v[160:175]
  v_mfma_f32_32x32x16_bf16 v[240:255], v[48:51], v[20:23], 0
  ds_read_b64_tr_b16 v[60:61], v88 offset:6144
  ds_read_b64_tr_b16 v[62:63], v88 offset:6656
  ds_read_b128 v[36:39], v78 offset:4096
  v_mfma_f32_32x32x16_bf16 v[176:191], v[136:139], v[116:119], v[176:191]
  s_waitcnt lgkmcnt(6)
  v_mfma_f32_32x32x16_bf16 v[240:255], v[52:55], v[28:31], v[240:255]
  ds_read_b128 v[40:43], v79 offset:0
  v_add_f32 v72, v72, v73
  v_cvt_pk_bf16_f32 v73, v72, v72
  v_and_b32 v73, 0xffff0000, v73
  v_sub_f32 v74, v72, v73
  v_mov_b32 v139, 0
  v_cvt_pk_bf16_f32 v137, v73, v109
  v_cvt_pk_bf16_f32 v138, v109, 0
  v_cvt_pk_bf16_f32 v136, v73, v74
  s_nop 1
  v_mfma_f32_32x32x16_bf16 v[192:207], v[136:139], v[112:115], v[192:207]
  v_mfma_f32_16x16x32_bf16 v[90:93], v[64:67], v[48:51], 0
  v_mfma_f32_32x32x16_bf16 v[224:239], v[52:55], v[24:27], v[224:239]
  ds_read_b128 v[44:47], v79 offset:4096
  v_mfma_f32_32x32x16_bf16 v[208:223], v[136:139], v[116:119], v[208:223]
  s_lshl_b32 s76, s65, 1
  s_add_u32 s76, s76, s68
  s_mul_i32 s81, s76, 6144
  s_add_u32 s81, s81, 8912896
  s_waitcnt lgkmcnt(2)
  v_mfma_f32_32x32x16_bf16 v[224:239], v[56:59], v[32:35], v[224:239]
  s_barrier
  ds_read_b64_tr_b16 v[48:49], v86 offset:0
  ds_read_b64_tr_b16 v[50:51], v86 offset:512
  ds_read_b128 v[16:19], v76 offset:16384
  v_lshlrev_b32 v0, 7, v5
  v_mul_f32 v128, v160, v160
  v_mul_f32 v129, v161, v161
  v_mul_f32 v130, v162, v162
  v_mul_f32 v131, v163, v163
  v_mul_f32 v132, v164, v164
  v_mul_f32 v133, v165, v165
  v_mul_f32 v134, v166, v166
  v_mul_f32 v135, v167, v167
  v_fma_f32 v128, v128, v122, v120
  v_fma_f32 v129, v129, v122, v120
  v_mfma_f32_32x32x16_bf16 v[240:255], v[56:59], v[36:39], v[240:255]
  ds_read_b64_tr_b16 v[52:53], v89 offset:2048
  ds_read_b64_tr_b16 v[54:55], v89 offset:2560
  ds_read_b128 v[20:23], v76 offset:20480
  v_fma_f32 v130, v130, v122, v120
  v_fma_f32 v131, v131, v122, v120
  v_fma_f32 v132, v132, v122, v120
  v_fma_f32 v133, v133, v122, v120
  v_fma_f32 v134, v134, v122, v120
  v_fma_f32 v135, v135, v122, v120
  v_mul_f32 v128, v160, v128
  v_mul_f32 v129, v161, v129
  v_mul_f32 v130, v162, v130
  v_mul_f32 v131, v163, v131
  v_mul_f32 v132, v164, v132
  s_waitcnt lgkmcnt(6)
  v_mfma_f32_32x32x16_bf16 v[240:255], v[60:63], v[44:47], v[240:255]
  ds_read_b128 v[24:27], v77 offset:16384
  v_mul_f32 v133, v165, v133
  v_mul_f32 v134, v166, v134
  v_mul_f32 v135, v167, v135
  v_exp_f32 v128, v128
  v_exp_f32 v129, v129
  v_exp_f32 v130, v130
  v_exp_f32 v131, v131
  v_exp_f32 v132, v132
  v_mfma_f32_16x16x32_bf16 v[90:93], v[64:67], v[56:59], v[90:93]
  v_mfma_f32_32x32x16_bf16 v[224:239], v[60:63], v[40:43], v[224:239]
  ds_read_b128 v[28:31], v77 offset:20480
  v_exp_f32 v133, v133
  v_exp_f32 v134, v134
  v_exp_f32 v135, v135
  v_fma_f32 v128, v128, v102, v102
  v_fma_f32 v129, v129, v102, v102
  v_fma_f32 v130, v130, v102, v102
  v_fma_f32 v131, v131, v102, v102
  v_fma_f32 v132, v132, v102, v102
  v_fma_f32 v133, v133, v102, v102
  v_fma_f32 v134, v134, v102, v102
  v_fma_f32 v135, v135, v102, v102
  s_waitcnt lgkmcnt(2)
  v_mfma_f32_32x32x16_bf16 v[224:239], v[48:51], v[16:19], v[224:239]
  ds_read_b64_tr_b16 v[56:57], v86 offset:4096
  ds_read_b64_tr_b16 v[58:59], v86 offset:4608
  ds_read_b128 v[32:35], v78 offset:16384
  v_rcp_f32 v128, v128
  v_rcp_f32 v129, v129
  v_rcp_f32 v130, v130
  v_rcp_f32 v131, v131
  v_rcp_f32 v132, v132
  v_rcp_f32 v133, v133
  v_mfma_f32_32x32x16_bf16 v[240:255], v[48:51], v[20:23], v[240:255]
  ds_read_b64_tr_b16 v[60:61], v89 offset:6144
  ds_read_b64_tr_b16 v[62:63], v89 offset:6656
  ds_read_b128 v[36:39], v78 offset:20480
  v_rcp_f32 v134, v134
  v_rcp_f32 v135, v135
  v_mul_f32 v128, v160, v128
  v_mul_f32 v129, v161, v129
  v_mul_f32 v130, v162, v130
  v_mul_f32 v131, v163, v131
  v_mul_f32 v132, v164, v132
  v_mul_f32 v133, v165, v133
  v_mul_f32 v134, v166, v134
  v_mul_f32 v135, v167, v135
  s_waitcnt lgkmcnt(6)
  v_mfma_f32_32x32x16_bf16 v[240:255], v[52:55], v[28:31], v[240:255]
  ds_read_b128 v[40:43], v79 offset:16384
  v_cvt_pk_bf16_f32 v136, v128, v129
  v_cvt_pk_bf16_f32 v137, v130, v131
  v_cvt_pk_bf16_f32 v138, v132, v133
  v_cvt_pk_bf16_f32 v139, v134, v135
  s_add_u32 s3, s4, 0
  buffer_store_dwordx4 v[136:139], v12, s[44:47], s3 offen sc1
  v_mul_f32 v128, v168, v168
  v_mul_f32 v129, v169, v169
  v_mul_f32 v130, v170, v170
  v_mul_f32 v131, v171, v171
  v_mul_f32 v132, v172, v172
  v_mul_f32 v133, v173, v173
  v_mul_f32 v134, v174, v174
  v_mul_f32 v135, v175, v175
  v_fma_f32 v128, v128, v122, v120
  v_mfma_f32_16x16x32_bf16 v[90:93], v[64:67], v[48:51], v[90:93]
  v_mfma_f32_32x32x16_bf16 v[224:239], v[52:55], v[24:27], v[224:239]
  ds_read_b128 v[44:47], v79 offset:20480
  v_fma_f32 v129, v129, v122, v120
  v_fma_f32 v130, v130, v122, v120
  v_fma_f32 v131, v131, v122, v120
  v_fma_f32 v132, v132, v122, v120
  v_fma_f32 v133, v133, v122, v120
  v_fma_f32 v134, v134, v122, v120
  v_fma_f32 v135, v135, v122, v120
  v_mul_f32 v128, v168, v128
  v_mul_f32 v129, v169, v129
  v_mul_f32 v130, v170, v130
  v_mul_f32 v131, v171, v131
  v_mul_f32 v132, v172, v132
  v_mul_f32 v133, v173, v133
  s_waitcnt lgkmcnt(2)
  v_mfma_f32_32x32x16_bf16 v[224:239], v[56:59], v[32:35], v[224:239]
  s_barrier
  ds_read_b64_tr_b16 v[48:49], v84 offset:0
  ds_read_b64_tr_b16 v[50:51], v84 offset:512
  ds_read_b128 v[16:19], v76 offset:32768
  v_mul_f32 v134, v174, v134
  v_mul_f32 v135, v175, v135
  v_exp_f32 v128, v128
  v_exp_f32 v129, v129
  v_exp_f32 v130, v130
  v_exp_f32 v131, v131
  v_exp_f32 v132, v132
  v_mfma_f32_32x32x16_bf16 v[240:255], v[56:59], v[36:39], v[240:255]
  ds_read_b64_tr_b16 v[52:53], v87 offset:2048
  ds_read_b64_tr_b16 v[54:55], v87 offset:2560
  ds_read_b128 v[20:23], v76 offset:36864
  v_exp_f32 v133, v133
  v_exp_f32 v134, v134
  v_exp_f32 v135, v135
  v_fma_f32 v128, v128, v102, v102
  v_fma_f32 v129, v129, v102, v102
  v_fma_f32 v130, v130, v102, v102
  v_fma_f32 v131, v131, v102, v102
  v_fma_f32 v132, v132, v102, v102
  s_waitcnt lgkmcnt(6)
  v_mfma_f32_32x32x16_bf16 v[240:255], v[60:63], v[44:47], v[240:255]
  ds_read_b128 v[24:27], v77 offset:32768
  v_fma_f32 v133, v133, v102, v102
  v_fma_f32 v134, v134, v102, v102
  v_fma_f32 v135, v135, v102, v102
  v_rcp_f32 v128, v128
  v_rcp_f32 v129, v129
  v_rcp_f32 v130, v130
  v_rcp_f32 v131, v131
  v_rcp_f32 v132, v132
  v_mfma_f32_16x16x32_bf16 v[90:93], v[64:67], v[56:59], v[90:93]
  v_mfma_f32_32x32x16_bf16 v[224:239], v[60:63], v[40:43], v[224:239]
  ds_read_b128 v[28:31], v77 offset:36864
  v_rcp_f32 v133, v133
  v_rcp_f32 v134, v134
  v_rcp_f32 v135, v135
  v_mul_f32 v128, v168, v128
  v_mul_f32 v129, v169, v129
  v_mul_f32 v130, v170, v130
  v_mul_f32 v131, v171, v131
  v_mul_f32 v132, v172, v132
  v_mul_f32 v133, v173, v133
  v_mul_f32 v134, v174, v134
  v_mul_f32 v135, v175, v135
  v_cvt_pk_bf16_f32 v140, v128, v129
  s_waitcnt lgkmcnt(2)
  v_mfma_f32_32x32x16_bf16 v[224:239], v[48:51], v[16:19], v[224:239]
  ds_read_b64_tr_b16 v[56:57], v84 offset:4096
  ds_read_b64_tr_b16 v[58:59], v84 offset:4608
  ds_read_b128 v[32:35], v78 offset:32768
  v_cvt_pk_bf16_f32 v141, v130, v131
  v_cvt_pk_bf16_f32 v142, v132, v133
  v_cvt_pk_bf16_f32 v143, v134, v135
  s_add_u32 s3, s4, 65536
  buffer_store_dwordx4 v[140:143], v12, s[44:47], s3 offen sc1
  v_mul_f32 v128, v176, v176
  v_mul_f32 v129, v177, v177
  v_mul_f32 v130, v178, v178
  v_mul_f32 v131, v179, v179
  v_mul_f32 v132, v180, v180
  v_mul_f32 v133, v181, v181
  v_mul_f32 v134, v182, v182
  v_mfma_f32_32x32x16_bf16 v[240:255], v[48:51], v[20:23], v[240:255]
  ds_read_b64_tr_b16 v[60:61], v87 offset:6144
  ds_read_b64_tr_b16 v[62:63], v87 offset:6656
  ds_read_b128 v[36:39], v78 offset:36864
  v_mul_f32 v135, v183, v183
  v_fma_f32 v128, v128, v123, v121
  v_fma_f32 v129, v129, v123, v121
  v_fma_f32 v130, v130, v123, v121
  v_fma_f32 v131, v131, v123, v121
  v_fma_f32 v132, v132, v123, v121
  v_fma_f32 v133, v133, v123, v121
  v_fma_f32 v134, v134, v123, v121
  v_fma_f32 v135, v135, v123, v121
  v_mul_f32 v128, v176, v128
  v_mul_f32 v129, v177, v129
  s_waitcnt lgkmcnt(6)
  v_mfma_f32_32x32x16_bf16 v[240:255], v[52:55], v[28:31], v[240:255]
  ds_read_b128 v[40:43], v79 offset:32768
  v_mul_f32 v130, v178, v130
  v_mul_f32 v131, v179, v131
  v_mul_f32 v132, v180, v132
  v_mul_f32 v133, v181, v133
  v_mul_f32 v134, v182, v134
  v_mul_f32 v135, v183, v135
  v_exp_f32 v128, v128
  v_exp_f32 v129, v129
  v_exp_f32 v130, v130
  v_exp_f32 v131, v131
  v_mfma_f32_16x16x32_bf16 v[90:93], v[64:67], v[48:51], v[90:93]
  v_mfma_f32_32x32x16_bf16 v[224:239], v[52:55], v[24:27], v[224:239]
  ds_read_b128 v[44:47], v79 offset:36864
  v_exp_f32 v132, v132
  v_exp_f32 v133, v133
  v_exp_f32 v134, v134
  v_exp_f32 v135, v135
  v_fma_f32 v128, v128, v106, v106
  v_fma_f32 v129, v129, v106, v106
  v_fma_f32 v130, v130, v106, v106
  v_fma_f32 v131, v131, v106, v106
  v_fma_f32 v132, v132, v106, v106
  v_fma_f32 v133, v133, v106, v106
  s_waitcnt lgkmcnt(2)
  v_mfma_f32_32x32x16_bf16 v[224:239], v[56:59], v[32:35], v[224:239]
  s_barrier
  ds_read_b64_tr_b16 v[48:49], v85 offset:0
  ds_read_b64_tr_b16 v[50:51], v85 offset:512
  ds_read_b128 v[16:19], v76 offset:49152
  v_fma_f32 v134, v134, v106, v106
  v_fma_f32 v135, v135, v106, v106
  v_rcp_f32 v128, v128
  v_rcp_f32 v129, v129
  v_rcp_f32 v130, v130
  v_rcp_f32 v131, v131
  v_mfma_f32_32x32x16_bf16 v[240:255], v[56:59], v[36:39], v[240:255]
  ds_read_b64_tr_b16 v[52:53], v88 offset:2048
  ds_read_b64_tr_b16 v[54:55], v88 offset:2560
  ds_read_b128 v[20:23], v76 offset:53248
  v_rcp_f32 v132, v132
  v_rcp_f32 v133, v133
  v_rcp_f32 v134, v134
  v_rcp_f32 v135, v135
  v_mul_f32 v128, v176, v128
  v_mul_f32 v129, v177, v129
  v_mul_f32 v130, v178, v130
  v_mul_f32 v131, v179, v131
  v_mul_f32 v132, v180, v132
  v_mul_f32 v133, v181, v133
  s_waitcnt lgkmcnt(6)
  v_mfma_f32_32x32x16_bf16 v[240:255], v[60:63], v[44:47], v[240:255]
  ds_read_b128 v[24:27], v77 offset:49152
  v_mul_f32 v134, v182, v134
  v_mul_f32 v135, v183, v135
  v_cvt_pk_bf16_f32 v136, v128, v129
  v_cvt_pk_bf16_f32 v137, v130, v131
  v_cvt_pk_bf16_f32 v138, v132, v133
  v_cvt_pk_bf16_f32 v139, v134, v135
  s_add_u32 s3, s4, 131072
  buffer_store_dwordx4 v[136:139], v12, s[44:47], s3 offen sc1
  v_mul_f32 v128, v184, v184
  v_mul_f32 v129, v185, v185
  v_mul_f32 v130, v186, v186
  v_mul_f32 v131, v187, v187
  v_mul_f32 v132, v188, v188
  v_mul_f32 v133, v189, v189
  v_mfma_f32_16x16x32_bf16 v[90:93], v[64:67], v[56:59], v[90:93]
  v_mfma_f32_32x32x16_bf16 v[224:239], v[60:63], v[40:43], v[224:239]
  ds_read_b128 v[28:31], v77 offset:53248
  v_mul_f32 v134, v190, v190
  v_mul_f32 v135, v191, v191
  v_fma_f32 v128, v128, v123, v121
  v_fma_f32 v129, v129, v123, v121
  v_fma_f32 v130, v130, v123, v121
  v_fma_f32 v131, v131, v123, v121
  v_fma_f32 v132, v132, v123, v121
  v_fma_f32 v133, v133, v123, v121
  v_fma_f32 v134, v134, v123, v121
  v_fma_f32 v135, v135, v123, v121
  v_mul_f32 v128, v184, v128
  v_mul_f32 v129, v185, v129
  v_mul_f32 v130, v186, v130
  s_waitcnt lgkmcnt(2)
  v_mfma_f32_32x32x16_bf16 v[224:239], v[48:51], v[16:19], v[224:239]
  ds_read_b64_tr_b16 v[56:57], v85 offset:4096
  ds_read_b64_tr_b16 v[58:59], v85 offset:4608
  ds_read_b128 v[32:35], v78 offset:49152
  v_mul_f32 v131, v187, v131
  v_mul_f32 v132, v188, v132
  v_mul_f32 v133, v189, v133
  v_mul_f32 v134, v190, v134
  v_mul_f32 v135, v191, v135
  v_exp_f32 v128, v128
  v_exp_f32 v129, v129
  v_exp_f32 v130, v130
  v_mfma_f32_32x32x16_bf16 v[240:255], v[48:51], v[20:23], v[240:255]
  ds_read_b64_tr_b16 v[60:61], v88 offset:6144
  ds_read_b64_tr_b16 v[62:63], v88 offset:6656
  ds_read_b128 v[36:39], v78 offset:53248
  v_exp_f32 v131, v131
  v_exp_f32 v132, v132
  v_exp_f32 v133, v133
  v_exp_f32 v134, v134
  v_exp_f32 v135, v135
  v_fma_f32 v128, v128, v106, v106
  v_fma_f32 v129, v129, v106, v106
  s_waitcnt lgkmcnt(6)
  v_mfma_f32_32x32x16_bf16 v[240:255], v[52:55], v[28:31], v[240:255]
  ds_read_b128 v[40:43], v79 offset:49152
  v_fma_f32 v130, v130, v106, v106
  v_fma_f32 v131, v131, v106, v106
  v_fma_f32 v132, v132, v106, v106
  v_fma_f32 v133, v133, v106, v106
  v_fma_f32 v134, v134, v106, v106
  v_fma_f32 v135, v135, v106, v106
  v_rcp_f32 v128, v128
  v_rcp_f32 v129, v129
  v_rcp_f32 v130, v130
  v_rcp_f32 v131, v131
  v_mfma_f32_16x16x32_bf16 v[90:93], v[64:67], v[48:51], v[90:93]
  v_mfma_f32_32x32x16_bf16 v[224:239], v[52:55], v[24:27], v[224:239]
  ds_read_b128 v[44:47], v79 offset:53248
  v_rcp_f32 v132, v132
  v_rcp_f32 v133, v133
  v_rcp_f32 v134, v134
  v_rcp_f32 v135, v135
  v_mul_f32 v128, v184, v128
  v_mul_f32 v129, v185, v129
  v_mul_f32 v130, v186, v130
  v_mul_f32 v131, v187, v131
  v_mul_f32 v132, v188, v132
  v_mul_f32 v133, v189, v133
  v_mul_f32 v134, v190, v134
  s_waitcnt lgkmcnt(2)
  v_mfma_f32_32x32x16_bf16 v[224:239], v[56:59], v[32:35], v[224:239]
  s_barrier
  ds_read_b64_tr_b16 v[48:49], v86 offset:0
  ds_read_b64_tr_b16 v[50:51], v86 offset:512
  ds_read_b128 v[16:19], v80 offset:0
  v_mul_f32 v135, v191, v135
  v_cvt_pk_bf16_f32 v140, v128, v129
  v_cvt_pk_bf16_f32 v141, v130, v131
  v_cvt_pk_bf16_f32 v142, v132, v133
  v_cvt_pk_bf16_f32 v143, v134, v135
  s_add_u32 s3, s4, 196608
  buffer_store_dwordx4 v[140:143], v12, s[44:47], s3 offen sc1
  v_mul_f32 v128, v192, v192
  v_mul_f32 v129, v193, v193
  v_mul_f32 v130, v194, v194
  v_mul_f32 v131, v195, v195
  v_mfma_f32_32x32x16_bf16 v[240:255], v[56:59], v[36:39], v[240:255]
  ds_read_b64_tr_b16 v[52:53], v89 offset:2048
  ds_read_b64_tr_b16 v[54:55], v89 offset:2560
  ds_read_b128 v[20:23], v80 offset:4096
  v_mul_f32 v132, v196, v196
  v_mul_f32 v133, v197, v197
  v_mul_f32 v134, v198, v198
  v_mul_f32 v135, v199, v199
  v_fma_f32 v128, v128, v122, v120
  v_fma_f32 v129, v129, v122, v120
  v_fma_f32 v130, v130, v122, v120
  v_fma_f32 v131, v131, v122, v120
  v_fma_f32 v132, v132, v122, v120
  v_fma_f32 v133, v133, v122, v120
  v_fma_f32 v134, v134, v122, v120
  s_waitcnt lgkmcnt(6)
  v_mfma_f32_32x32x16_bf16 v[240:255], v[60:63], v[44:47], v[240:255]
  ds_read_b128 v[24:27], v81 offset:0
  v_fma_f32 v135, v135, v122, v120
  v_mul_f32 v128, v192, v128
  v_mul_f32 v129, v193, v129
  v_mul_f32 v130, v194, v130
  v_mul_f32 v131, v195, v131
  v_mul_f32 v132, v196, v132
  v_mul_f32 v133, v197, v133
  v_mul_f32 v134, v198, v134
  v_mul_f32 v135, v199, v135
  v_exp_f32 v128, v128
  v_exp_f32 v129, v129
  v_mfma_f32_16x16x32_bf16 v[90:93], v[64:67], v[56:59], v[90:93]
  v_mfma_f32_32x32x16_bf16 v[224:239], v[60:63], v[40:43], v[224:239]
  ds_read_b128 v[28:31], v81 offset:4096
  v_exp_f32 v130, v130
  v_exp_f32 v131, v131
  v_exp_f32 v132, v132
  v_exp_f32 v133, v133
  v_exp_f32 v134, v134
  v_exp_f32 v135, v135
  v_fma_f32 v128, v128, v102, v102
  v_fma_f32 v129, v129, v102, v102
  v_fma_f32 v130, v130, v102, v102
  s_waitcnt lgkmcnt(2)
  v_mfma_f32_32x32x16_bf16 v[224:239], v[48:51], v[16:19], v[224:239]
  ds_read_b64_tr_b16 v[56:57], v86 offset:4096
  ds_read_b64_tr_b16 v[58:59], v86 offset:4608
  ds_read_b128 v[32:35], v82 offset:0
  v_fma_f32 v131, v131, v102, v102
  v_fma_f32 v132, v132, v102, v102
  v_fma_f32 v133, v133, v102, v102
  v_fma_f32 v134, v134, v102, v102
  v_fma_f32 v135, v135, v102, v102
  v_rcp_f32 v128, v128
  v_rcp_f32 v129, v129
  v_rcp_f32 v130, v130
  v_mfma_f32_32x32x16_bf16 v[240:255], v[48:51], v[20:23], v[240:255]
  ds_read_b64_tr_b16 v[60:61], v89 offset:6144
  ds_read_b64_tr_b16 v[62:63], v89 offset:6656
  ds_read_b128 v[36:39], v82 offset:4096
  v_rcp_f32 v131, v131
  v_rcp_f32 v132, v132
  v_rcp_f32 v133, v133
  v_rcp_f32 v134, v134
  v_rcp_f32 v135, v135
  v_mul_f32 v128, v192, v128
  v_mul_f32 v129, v193, v129
  v_mul_f32 v130, v194, v130
  s_waitcnt lgkmcnt(6)
  v_mfma_f32_32x32x16_bf16 v[240:255], v[52:55], v[28:31], v[240:255]
  ds_read_b128 v[40:43], v83 offset:0
  v_mul_f32 v131, v195, v131
  v_mul_f32 v132, v196, v132
  v_mul_f32 v133, v197, v133
  v_mul_f32 v134, v198, v134
  v_mul_f32 v135, v199, v135
  v_cvt_pk_bf16_f32 v136, v128, v129
  v_cvt_pk_bf16_f32 v137, v130, v131
  v_cvt_pk_bf16_f32 v138, v132, v133
  v_cvt_pk_bf16_f32 v139, v134, v135
  s_add_u32 s3, s5, 0
  buffer_store_dwordx4 v[136:139], v13, s[44:47], s3 offen sc1
  v_mul_f32 v128, v200, v200
  v_mul_f32 v129, v201, v201
  v_mul_f32 v130, v202, v202
  v_mfma_f32_16x16x32_bf16 v[90:93], v[64:67], v[48:51], v[90:93]
  v_mfma_f32_32x32x16_bf16 v[224:239], v[52:55], v[24:27], v[224:239]
  ds_read_b128 v[44:47], v83 offset:4096
  v_mul_f32 v131, v203, v203
  v_mul_f32 v132, v204, v204
  v_mul_f32 v133, v205, v205
  v_mul_f32 v134, v206, v206
  v_mul_f32 v135, v207, v207
  v_fma_f32 v128, v128, v122, v120
  v_fma_f32 v129, v129, v122, v120
  v_fma_f32 v130, v130, v122, v120
  v_fma_f32 v131, v131, v122, v120
  v_fma_f32 v132, v132, v122, v120
  v_fma_f32 v133, v133, v122, v120
  v_fma_f32 v134, v134, v122, v120
  v_fma_f32 v135, v135, v122, v120
  s_waitcnt lgkmcnt(2)
  v_mfma_f32_32x32x16_bf16 v[224:239], v[56:59], v[32:35], v[224:239]
  s_barrier
  ds_read_b64_tr_b16 v[48:49], v84 offset:0
  ds_read_b64_tr_b16 v[50:51], v84 offset:512
  ds_read_b128 v[16:19], v80 offset:16384
  v_mul_f32 v128, v200, v128
  v_mul_f32 v129, v201, v129
  v_mul_f32 v130, v202, v130
  v_mul_f32 v131, v203, v131
  v_mul_f32 v132, v204, v132
  v_mul_f32 v133, v205, v133
  v_mul_f32 v134, v206, v134
  v_mul_f32 v135, v207, v135
  v_exp_f32 v128, v128
  v_exp_f32 v129, v129
  v_mfma_f32_32x32x16_bf16 v[240:255], v[56:59], v[36:39], v[240:255]
  ds_read_b64_tr_b16 v[52:53], v87 offset:2048
  ds_read_b64_tr_b16 v[54:55], v87 offset:2560
  ds_read_b128 v[20:23], v80 offset:20480
  v_exp_f32 v130, v130
  v_exp_f32 v131, v131
  v_exp_f32 v132, v132
  v_exp_f32 v133, v133
  v_exp_f32 v134, v134
  v_exp_f32 v135, v135
  s_waitcnt lgkmcnt(6)
  v_mfma_f32_32x32x16_bf16 v[240:255], v[60:63], v[44:47], v[240:255]
  ds_read_b128 v[24:27], v81 offset:16384
  v_fma_f32 v128, v128, v102, v102
  v_fma_f32 v129, v129, v102, v102
  v_fma_f32 v130, v130, v102, v102
  v_fma_f32 v131, v131, v102, v102
  v_fma_f32 v132, v132, v102, v102
  v_fma_f32 v133, v133, v102, v102
  v_fma_f32 v134, v134, v102, v102
  v_fma_f32 v135, v135, v102, v102
  v_rcp_f32 v128, v128
  v_rcp_f32 v129, v129
  v_mfma_f32_16x16x32_bf16 v[90:93], v[64:67], v[56:59], v[90:93]
  v_mfma_f32_32x32x16_bf16 v[224:239], v[60:63], v[40:43], v[224:239]
  ds_read_b128 v[28:31], v81 offset:20480
  v_rcp_f32 v130, v130
  v_rcp_f32 v131, v131
  v_rcp_f32 v132, v132
  v_rcp_f32 v133, v133
  v_rcp_f32 v134, v134
  v_rcp_f32 v135, v135
  v_mul_f32 v128, v200, v128
  v_mul_f32 v129, v201, v129
  v_mul_f32 v130, v202, v130
  v_mul_f32 v131, v203, v131
  s_waitcnt lgkmcnt(2)
  v_mfma_f32_32x32x16_bf16 v[224:239], v[48:51], v[16:19], v[224:239]
  ds_read_b64_tr_b16 v[56:57], v84 offset:4096
  ds_read_b64_tr_b16 v[58:59], v84 offset:4608
  ds_read_b128 v[32:35], v82 offset:16384
  v_mul_f32 v132, v204, v132
  v_mul_f32 v133, v205, v133
  v_mul_f32 v134, v206, v134
  v_mul_f32 v135, v207, v135
  v_cvt_pk_bf16_f32 v140, v128, v129
  v_cvt_pk_bf16_f32 v141, v130, v131
  v_cvt_pk_bf16_f32 v142, v132, v133
  s_waitcnt vmcnt(1)
  v_mov_b32 v11, s73
  buffer_store_dword v11, v7, s[44:47], s27 offen sc1
  s_add_u32 s27, s27, 2048
  v_mfma_f32_32x32x16_bf16 v[240:255], v[48:51], v[20:23], v[240:255]
  ds_read_b64_tr_b16 v[60:61], v87 offset:6144
  ds_read_b64_tr_b16 v[62:63], v87 offset:6656
  ds_read_b128 v[36:39], v82 offset:20480
  v_cvt_pk_bf16_f32 v143, v134, v135
  s_add_u32 s3, s5, 65536
  buffer_store_dwordx4 v[140:143], v13, s[44:47], s3 offen sc1
  v_mul_f32 v128, v208, v208
  v_mul_f32 v129, v209, v209
  v_mul_f32 v130, v210, v210
  v_mul_f32 v131, v211, v211
  v_mul_f32 v132, v212, v212
  v_mul_f32 v133, v213, v213
  v_mul_f32 v134, v214, v214
  v_mul_f32 v135, v215, v215
  v_fma_f32 v128, v128, v123, v121
  s_waitcnt lgkmcnt(6)
  v_mfma_f32_32x32x16_bf16 v[240:255], v[52:55], v[28:31], v[240:255]
  ds_read_b128 v[40:43], v83 offset:16384
  v_fma_f32 v129, v129, v123, v121
  v_fma_f32 v130, v130, v123, v121
  v_fma_f32 v131, v131, v123, v121
  v_fma_f32 v132, v132, v123, v121
  v_fma_f32 v133, v133, v123, v121
  v_fma_f32 v134, v134, v123, v121
  v_fma_f32 v135, v135, v123, v121
  v_mul_f32 v128, v208, v128
  v_mul_f32 v129, v209, v129
  v_mul_f32 v130, v210, v130
  v_mul_f32 v131, v211, v131
  v_mul_f32 v132, v212, v132
  v_mul_f32 v133, v213, v133
  v_mfma_f32_16x16x32_bf16 v[90:93], v[64:67], v[48:51], v[90:93]
  v_mfma_f32_32x32x16_bf16 v[224:239], v[52:55], v[24:27], v[224:239]
  ds_read_b128 v[44:47], v83 offset:20480
  v_mul_f32 v134, v214, v134
  v_mul_f32 v135, v215, v135
  v_exp_f32 v128, v128
  v_exp_f32 v129, v129
  v_exp_f32 v130, v130
  v_exp_f32 v131, v131
  v_exp_f32 v132, v132
  v_exp_f32 v133, v133
  s_waitcnt lgkmcnt(2)
  v_mfma_f32_32x32x16_bf16 v[224:239], v[56:59], v[32:35], v[224:239]
  s_barrier
  ds_read_b64_tr_b16 v[48:49], v85 offset:0
  ds_read_b64_tr_b16 v[50:51], v85 offset:512
  ds_read_b128 v[16:19], v80 offset:32768
  v_exp_f32 v134, v134
  v_exp_f32 v135, v135
  v_fma_f32 v128, v128, v106, v106
  v_fma_f32 v129, v129, v106, v106
  v_fma_f32 v130, v130, v106, v106
  v_fma_f32 v131, v131, v106, v106
  v_fma_f32 v132, v132, v106, v106
  v_fma_f32 v133, v133, v106, v106
  v_fma_f32 v134, v134, v106, v106
  v_mfma_f32_32x32x16_bf16 v[240:255], v[56:59], v[36:39], v[240:255]
  ds_read_b64_tr_b16 v[52:53], v88 offset:2048
  ds_read_b64_tr_b16 v[54:55], v88 offset:2560
  ds_read_b128 v[20:23], v80 offset:36864
  v_fma_f32 v135, v135, v106, v106
  v_rcp_f32 v128, v128
  v_rcp_f32 v129, v129
  v_rcp_f32 v130, v130
  v_rcp_f32 v131, v131
  v_rcp_f32 v132, v132
  s_waitcnt lgkmcnt(6)
  v_mfma_f32_32x32x16_bf16 v[240:255], v[60:63], v[44:47], v[240:255]
  ds_read_b128 v[24:27], v81 offset:32768
  v_rcp_f32 v133, v133
  v_rcp_f32 v134, v134
  v_rcp_f32 v135, v135
  v_mul_f32 v128, v208, v128
  v_mul_f32 v129, v209, v129
  v_mul_f32 v130, v210, v130
  v_mul_f32 v131, v211, v131
  v_mul_f32 v132, v212, v132
  v_mul_f32 v133, v213, v133
  v_mul_f32 v134, v214, v134
  v_mul_f32 v135, v215, v135
  v_cvt_pk_bf16_f32 v136, v128, v129
  v_mfma_f32_16x16x32_bf16 v[90:93], v[64:67], v[56:59], v[90:93]
  v_mfma_f32_32x32x16_bf16 v[224:239], v[60:63], v[40:43], v[224:239]
  ds_read_b128 v[28:31], v81 offset:36864
  v_cvt_pk_bf16_f32 v137, v130, v131
  v_cvt_pk_bf16_f32 v138, v132, v133
  v_cvt_pk_bf16_f32 v139, v134, v135
  s_add_u32 s3, s5, 131072
  buffer_store_dwordx4 v[136:139], v13, s[44:47], s3 offen sc1
  v_mul_f32 v128, v216, v216
  v_mul_f32 v129, v217, v217
  v_mul_f32 v130, v218, v218
  v_mul_f32 v131, v219, v219
  v_mul_f32 v132, v220, v220
  v_mul_f32 v133, v221, v221
  v_mul_f32 v134, v222, v222
  v_mul_f32 v135, v223, v223
  v_fma_f32 v128, v128, v123, v121
  v_fma_f32 v129, v129, v123, v121
  s_waitcnt lgkmcnt(2)
  v_mfma_f32_32x32x16_bf16 v[224:239], v[48:51], v[16:19], v[224:239]
  ds_read_b64_tr_b16 v[56:57], v85 offset:4096
  ds_read_b64_tr_b16 v[58:59], v85 offset:4608
  ds_read_b128 v[32:35], v82 offset:32768
  v_fma_f32 v130, v130, v123, v121
  v_fma_f32 v131, v131, v123, v121
  v_fma_f32 v132, v132, v123, v121
  v_fma_f32 v133, v133, v123, v121
  v_fma_f32 v134, v134, v123, v121
  v_fma_f32 v135, v135, v123, v121
  v_mul_f32 v128, v216, v128
  v_mul_f32 v129, v217, v129
  v_mul_f32 v130, v218, v130
  v_mul_f32 v131, v219, v131
  v_mfma_f32_32x32x16_bf16 v[240:255], v[48:51], v[20:23], v[240:255]
  ds_read_b64_tr_b16 v[60:61], v88 offset:6144
  ds_read_b64_tr_b16 v[62:63], v88 offset:6656
  ds_read_b128 v[36:39], v82 offset:36864
  v_mul_f32 v132, v220, v132
  v_mul_f32 v133, v221, v133
  v_mul_f32 v134, v222, v134
  v_mul_f32 v135, v223, v135
  v_exp_f32 v128, v128
  v_exp_f32 v129, v129
  v_exp_f32 v130, v130
  v_exp_f32 v131, v131
  s_waitcnt lgkmcnt(6)
  v_mfma_f32_32x32x16_bf16 v[240:255], v[52:55], v[28:31], v[240:255]
  ds_read_b128 v[40:43], v83 offset:32768
  v_exp_f32 v132, v132
  v_exp_f32 v133, v133
  v_exp_f32 v134, v134
  v_exp_f32 v135, v135
  v_fma_f32 v128, v128, v106, v106
  v_fma_f32 v129, v129, v106, v106
  v_fma_f32 v130, v130, v106, v106
  v_fma_f32 v131, v131, v106, v106
  v_fma_f32 v132, v132, v106, v106
  v_fma_f32 v133, v133, v106, v106
  v_mfma_f32_16x16x32_bf16 v[90:93], v[64:67], v[48:51], v[90:93]
  v_mfma_f32_32x32x16_bf16 v[224:239], v[52:55], v[24:27], v[224:239]
  ds_read_b128 v[44:47], v83 offset:36864
  v_fma_f32 v134, v134, v106, v106
  v_fma_f32 v135, v135, v106, v106
  v_rcp_f32 v128, v128
  v_rcp_f32 v129, v129
  v_rcp_f32 v130, v130
  v_rcp_f32 v131, v131
  v_rcp_f32 v132, v132
  v_rcp_f32 v133, v133
  s_waitcnt lgkmcnt(2)
  v_mfma_f32_32x32x16_bf16 v[224:239], v[56:59], v[32:35], v[224:239]
  s_barrier
  ds_read_b64_tr_b16 v[48:49], v86 offset:0
  ds_read_b64_tr_b16 v[50:51], v86 offset:512
  ds_read_b128 v[16:19], v80 offset:49152
  v_rcp_f32 v134, v134
  v_rcp_f32 v135, v135
  v_mul_f32 v128, v216, v128
  v_mul_f32 v129, v217, v129
  v_mul_f32 v130, v218, v130
  v_mul_f32 v131, v219, v131
  v_mul_f32 v132, v220, v132
  v_mul_f32 v133, v221, v133
  v_mul_f32 v134, v222, v134
  v_mul_f32 v135, v223, v135
  v_mfma_f32_32x32x16_bf16 v[240:255], v[56:59], v[36:39], v[240:255]
  ds_read_b64_tr_b16 v[52:53], v89 offset:2048
  ds_read_b64_tr_b16 v[54:55], v89 offset:2560
  ds_read_b128 v[20:23], v80 offset:53248
  v_cvt_pk_bf16_f32 v140, v128, v129
  v_cvt_pk_bf16_f32 v141, v130, v131
  v_cvt_pk_bf16_f32 v142, v132, v133
  v_cvt_pk_bf16_f32 v143, v134, v135
  s_add_u32 s3, s5, 196608
  buffer_store_dwordx4 v[140:143], v13, s[44:47], s3 offen sc1
  s_waitcnt lgkmcnt(6)
  v_mfma_f32_32x32x16_bf16 v[240:255], v[60:63], v[44:47], v[240:255]
  ds_read_b128 v[24:27], v81 offset:49152
  v_mfma_f32_16x16x32_bf16 v[90:93], v[64:67], v[56:59], v[90:93]
  v_mfma_f32_32x32x16_bf16 v[224:239], v[60:63], v[40:43], v[224:239]
  ds_read_b128 v[28:31], v81 offset:53248
  s_waitcnt lgkmcnt(2)
  v_mfma_f32_32x32x16_bf16 v[224:239], v[48:51], v[16:19], v[224:239]
  ds_read_b64_tr_b16 v[56:57], v86 offset:4096
  ds_read_b64_tr_b16 v[58:59], v86 offset:4608
  ds_read_b128 v[32:35], v82 offset:49152
  v_mfma_f32_32x32x16_bf16 v[240:255], v[48:51], v[20:23], v[240:255]
  ds_read_b64_tr_b16 v[60:61], v89 offset:6144
  ds_read_b64_tr_b16 v[62:63], v89 offset:6656
  ds_read_b128 v[36:39], v82 offset:53248
  s_waitcnt lgkmcnt(6)
  v_mfma_f32_32x32x16_bf16 v[240:255], v[52:55], v[28:31], v[240:255]
  ds_read_b128 v[40:43], v83 offset:49152
  v_mfma_f32_16x16x32_bf16 v[90:93], v[64:67], v[48:51], v[90:93]
  v_mfma_f32_32x32x16_bf16 v[224:239], v[52:55], v[24:27], v[224:239]
  ds_read_b128 v[44:47], v83 offset:53248
  s_waitcnt lgkmcnt(2)
  v_mfma_f32_16x16x32_bf16 v[90:93], v[64:67], v[56:59], v[90:93]
  v_mfma_f32_32x32x16_bf16 v[224:239], v[56:59], v[32:35], v[224:239]
  ds_read_b64 v[76:77], v124
  v_xor_b32 v8, 16, v124
  ds_read_b64 v[78:79], v8
  v_xor_b32 v8, 32, v124
  ds_read_b64 v[80:81], v8
  v_xor_b32 v8, 48, v124
  ds_read_b64 v[82:83], v8
  v_mfma_f32_32x32x16_bf16 v[240:255], v[56:59], v[36:39], v[240:255]
  ds_write_b32 v94, v90 offset:256
  s_waitcnt lgkmcnt(5)
  v_mfma_f32_32x32x16_bf16 v[240:255], v[60:63], v[44:47], v[240:255]
  s_waitcnt lgkmcnt(0)
  s_barrier
  ds_read_b32 v91, v95 offset:256
  v_mfma_f32_32x32x16_bf16 v[224:239], v[60:63], v[40:43], v[224:239]
  buffer_load_dword v158, v0, s[44:47], s81 offen sc1
  s_waitcnt lgkmcnt(0)
  v_add_f32 v90, v90, v91
  v_cvt_pk_bf16_f32 v91, v90, v90
  v_and_b32 v91, 0xffff0000, v91
  v_sub_f32 v92, v90, v91
  v_mov_b32 v139, 0
  v_cvt_pk_bf16_f32 v137, v91, v110
  v_cvt_pk_bf16_f32 v138, v110, 0
  v_cvt_pk_bf16_f32 v136, v91, v92
  s_nop 1
  v_mfma_f32_32x32x16_bf16 v[224:239], v[136:139], v[112:115], v[224:239]
  v_mfma_f32_32x32x16_bf16 v[240:255], v[136:139], v[116:119], v[240:255]
  s_nop 10
  v_pk_mul_f32 v[128:129], v[224:225], v[224:225]
  v_pk_mul_f32 v[130:131], v[226:227], v[226:227]
  v_pk_mul_f32 v[132:133], v[228:229], v[228:229]
  v_pk_mul_f32 v[134:135], v[230:231], v[230:231]
  v_pk_fma_f32 v[128:129], v[128:129], v[122:123], v[120:121] op_sel:[0,0,0] op_sel_hi:[1,0,0]
  v_pk_fma_f32 v[130:131], v[130:131], v[122:123], v[120:121] op_sel:[0,0,0] op_sel_hi:[1,0,0]
  v_pk_fma_f32 v[132:133], v[132:133], v[122:123], v[120:121] op_sel:[0,0,0] op_sel_hi:[1,0,0]
  v_pk_fma_f32 v[134:135], v[134:135], v[122:123], v[120:121] op_sel:[0,0,0] op_sel_hi:[1,0,0]
  v_pk_mul_f32 v[128:129], v[224:225], v[128:129]
  v_pk_mul_f32 v[130:131], v[226:227], v[130:131]
  v_pk_mul_f32 v[132:133], v[228:229], v[132:133]
  v_pk_mul_f32 v[134:135], v[230:231], v[134:135]
  v_exp_f32 v128, v128
  v_exp_f32 v129, v129
  v_exp_f32 v130, v130
  v_exp_f32 v131, v131
  v_exp_f32 v132, v132
  v_exp_f32 v133, v133
  v_exp_f32 v134, v134
  v_exp_f32 v135, v135
  v_pk_fma_f32 v[128:129], v[128:129], v[102:103], v[102:103] op_sel:[0,0,0] op_sel_hi:[1,0,0]
  v_pk_fma_f32 v[130:131], v[130:131], v[102:103], v[102:103] op_sel:[0,0,0] op_sel_hi:[1,0,0]
  v_pk_fma_f32 v[132:133], v[132:133], v[102:103], v[102:103] op_sel:[0,0,0] op_sel_hi:[1,0,0]
  v_pk_fma_f32 v[134:135], v[134:135], v[102:103], v[102:103] op_sel:[0,0,0] op_sel_hi:[1,0,0]
  v_rcp_f32 v128, v128
  v_rcp_f32 v129, v129
  v_rcp_f32 v130, v130
  v_rcp_f32 v131, v131
  v_rcp_f32 v132, v132
  v_rcp_f32 v133, v133
  v_rcp_f32 v134, v134
  v_rcp_f32 v135, v135
  v_pk_mul_f32 v[128:129], v[224:225], v[128:129]
  v_pk_mul_f32 v[130:131], v[226:227], v[130:131]
  v_pk_mul_f32 v[132:133], v[228:229], v[132:133]
  v_pk_mul_f32 v[134:135], v[230:231], v[134:135]
  v_cvt_pk_bf16_f32 v136, v128, v129
  v_cvt_pk_bf16_f32 v137, v130, v131
  v_cvt_pk_bf16_f32 v138, v132, v133
  v_cvt_pk_bf16_f32 v139, v134, v135
  s_add_u32 s3, s6, 0
  buffer_store_dwordx4 v[136:139], v14, s[44:47], s3 offen sc1
  v_pk_mul_f32 v[128:129], v[232:233], v[232:233]
  v_pk_mul_f32 v[130:131], v[234:235], v[234:235]
  v_pk_mul_f32 v[132:133], v[236:237], v[236:237]
  v_pk_mul_f32 v[134:135], v[238:239], v[238:239]
  v_pk_fma_f32 v[128:129], v[128:129], v[122:123], v[120:121] op_sel:[0,0,0] op_sel_hi:[1,0,0]
  v_pk_fma_f32 v[130:131], v[130:131], v[122:123], v[120:121] op_sel:[0,0,0] op_sel_hi:[1,0,0]
  v_pk_fma_f32 v[132:133], v[132:133], v[122:123], v[120:121] op_sel:[0,0,0] op_sel_hi:[1,0,0]
  v_pk_fma_f32 v[134:135], v[134:135], v[122:123], v[120:121] op_sel:[0,0,0] op_sel_hi:[1,0,0]
  v_pk_mul_f32 v[128:129], v[232:233], v[128:129]
  v_pk_mul_f32 v[130:131], v[234:235], v[130:131]
  v_pk_mul_f32 v[132:133], v[236:237], v[132:133]
  v_pk_mul_f32 v[134:135], v[238:239], v[134:135]
  v_exp_f32 v128, v128
  v_exp_f32 v129, v129
  v_exp_f32 v130, v130
  v_exp_f32 v131, v131
  v_exp_f32 v132, v132
  v_exp_f32 v133, v133
  v_exp_f32 v134, v134
  v_exp_f32 v135, v135
  v_pk_fma_f32 v[128:129], v[128:129], v[102:103], v[102:103] op_sel:[0,0,0] op_sel_hi:[1,0,0]
  v_pk_fma_f32 v[130:131], v[130:131], v[102:103], v[102:103] op_sel:[0,0,0] op_sel_hi:[1,0,0]
  v_pk_fma_f32 v[132:133], v[132:133], v[102:103], v[102:103] op_sel:[0,0,0] op_sel_hi:[1,0,0]
  v_pk_fma_f32 v[134:135], v[134:135], v[102:103], v[102:103] op_sel:[0,0,0] op_sel_hi:[1,0,0]
  v_rcp_f32 v128, v128
  v_rcp_f32 v129, v129
  v_rcp_f32 v130, v130
  v_rcp_f32 v131, v131
  v_rcp_f32 v132, v132
  v_rcp_f32 v133, v133
  v_rcp_f32 v134, v134
  v_rcp_f32 v135, v135
  v_pk_mul_f32 v[128:129], v[232:233], v[128:129]
  v_pk_mul_f32 v[130:131], v[234:235], v[130:131]
  v_pk_mul_f32 v[132:133], v[236:237], v[132:133]
  v_pk_mul_f32 v[134:135], v[238:239], v[134:135]
  v_cvt_pk_bf16_f32 v140, v128, v129
  v_cvt_pk_bf16_f32 v141, v130, v131
  v_cvt_pk_bf16_f32 v142, v132, v133
  v_cvt_pk_bf16_f32 v143, v134, v135
  s_add_u32 s3, s6, 65536
  buffer_store_dwordx4 v[140:143], v14, s[44:47], s3 offen sc1
  v_pk_mul_f32 v[128:129], v[240:241], v[240:241]
  v_pk_mul_f32 v[130:131], v[242:243], v[242:243]
  v_pk_mul_f32 v[132:133], v[244:245], v[244:245]
  v_pk_mul_f32 v[134:135], v[246:247], v[246:247]
  v_pk_fma_f32 v[128:129], v[128:129], v[122:123], v[120:121] op_sel:[0,1,1] op_sel_hi:[1,1,1]
  v_pk_fma_f32 v[130:131], v[130:131], v[122:123], v[120:121] op_sel:[0,1,1] op_sel_hi:[1,1,1]
  v_pk_fma_f32 v[132:133], v[132:133], v[122:123], v[120:121] op_sel:[0,1,1] op_sel_hi:[1,1,1]
  v_pk_fma_f32 v[134:135], v[134:135], v[122:123], v[120:121] op_sel:[0,1,1] op_sel_hi:[1,1,1]
  v_pk_mul_f32 v[128:129], v[240:241], v[128:129]
  v_pk_mul_f32 v[130:131], v[242:243], v[130:131]
  v_pk_mul_f32 v[132:133], v[244:245], v[132:133]
  v_pk_mul_f32 v[134:135], v[246:247], v[134:135]
  v_exp_f32 v128, v128
  v_exp_f32 v129, v129
  v_exp_f32 v130, v130
  v_exp_f32 v131, v131
  v_exp_f32 v132, v132
  v_exp_f32 v133, v133
  v_exp_f32 v134, v134
  v_exp_f32 v135, v135
  v_pk_fma_f32 v[128:129], v[128:129], v[106:107], v[106:107] op_sel:[0,0,0] op_sel_hi:[1,0,0]
  v_pk_fma_f32 v[130:131], v[130:131], v[106:107], v[106:107] op_sel:[0,0,0] op_sel_hi:[1,0,0]
  v_pk_fma_f32 v[132:133], v[132:133], v[106:107], v[106:107] op_sel:[0,0,0] op_sel_hi:[1,0,0]
  v_pk_fma_f32 v[134:135], v[134:135], v[106:107], v[106:107] op_sel:[0,0,0] op_sel_hi:[1,0,0]
  v_rcp_f32 v128, v128
  v_rcp_f32 v129, v129
  v_rcp_f32 v130, v130
  v_rcp_f32 v131, v131
  v_rcp_f32 v132, v132
  v_rcp_f32 v133, v133
  v_rcp_f32 v134, v134
  v_rcp_f32 v135, v135
  v_pk_mul_f32 v[128:129], v[240:241], v[128:129]
  v_pk_mul_f32 v[130:131], v[242:243], v[130:131]
  v_pk_mul_f32 v[132:133], v[244:245], v[132:133]
  v_pk_mul_f32 v[134:135], v[246:247], v[134:135]
  v_cvt_pk_bf16_f32 v136, v128, v129
  v_cvt_pk_bf16_f32 v137, v130, v131
  v_cvt_pk_bf16_f32 v138, v132, v133
  v_cvt_pk_bf16_f32 v139, v134, v135
  s_add_u32 s3, s6, 131072
  buffer_store_dwordx4 v[136:139], v14, s[44:47], s3 offen sc1
  s_waitcnt vmcnt(4)
  v_mov_b32 v11, s73
  buffer_store_dword v11, v7, s[44:47], s27 offen sc1
  s_add_u32 s27, s27, 2048
  ds_read_b32 v159, v154
  s_waitcnt vmcnt(4)
  v_cmp_ne_u32 vcc, s73, v158
  s_cbranch_vccnz Lgc_43
Lgcok_44:
  buffer_load_dwordx4 v[16:19], v150, s[44:47], s70 offen offset:0 sc1
  buffer_load_dwordx4 v[20:23], v150, s[44:47], s70 offen offset:1024 sc1
  buffer_load_dwordx4 v[24:27], v150, s[44:47], s70 offen offset:2048 sc1
  buffer_load_dwordx4 v[28:31], v150, s[44:47], s70 offen offset:3072 sc1
  s_add_u32 s70, s70, 0x00001000
  buffer_load_dwordx4 v[32:35], v150, s[44:47], s70 offen offset:0 sc1
  buffer_load_dwordx4 v[36:39], v150, s[44:47], s70 offen offset:1024 sc1
  buffer_load_dwordx4 v[40:43], v150, s[44:47], s70 offen offset:2048 sc1
  buffer_load_dwordx4 v[44:47], v150, s[44:47], s70 offen offset:3072 sc1
  s_waitcnt lgkmcnt(0)
  v_cmp_gt_u32 vcc, 1, v159
  s_cbranch_vccnz Leb_47
Lebok_48:
  ds_read_b64_tr_b16 v[48:49], v144 offset:0
  ds_read_b64_tr_b16 v[50:51], v144 offset:1024
  ds_read_b64_tr_b16 v[52:53], v145 offset:0
  ds_read_b64_tr_b16 v[54:55], v145 offset:1024
  ds_read_b64_tr_b16 v[56:57], v144 offset:4096
  ds_read_b64_tr_b16 v[58:59], v144 offset:5120
  ds_read_b64_tr_b16 v[60:61], v145 offset:4096
  ds_read_b64_tr_b16 v[62:63], v145 offset:5120
  v_pk_mul_f32 v[128:129], v[248:249], v[248:249]
  v_pk_mul_f32 v[130:131], v[250:251], v[250:251]
  v_pk_mul_f32 v[132:133], v[252:253], v[252:253]
  v_pk_mul_f32 v[134:135], v[254:255], v[254:255]
  v_pk_fma_f32 v[128:129], v[128:129], v[122:123], v[120:121] op_sel:[0,1,1] op_sel_hi:[1,1,1]
  v_pk_fma_f32 v[130:131], v[130:131], v[122:123], v[120:121] op_sel:[0,1,1] op_sel_hi:[1,1,1]
  v_pk_fma_f32 v[132:133], v[132:133], v[122:123], v[120:121] op_sel:[0,1,1] op_sel_hi:[1,1,1]
  v_pk_fma_f32 v[134:135], v[134:135], v[122:123], v[120:121] op_sel:[0,1,1] op_sel_hi:[1,1,1]
  v_pk_mul_f32 v[128:129], v[248:249], v[128:129]
  v_pk_mul_f32 v[130:131], v[250:251], v[130:131]
  v_pk_mul_f32 v[132:133], v[252:253], v[132:133]
  v_pk_mul_f32 v[134:135], v[254:255], v[134:135]
  v_exp_f32 v128, v128
  v_exp_f32 v129, v129
  v_exp_f32 v130, v130
  v_exp_f32 v131, v131
  v_exp_f32 v132, v132
  v_exp_f32 v133, v133
  v_exp_f32 v134, v134
  v_exp_f32 v135, v135
  v_pk_fma_f32 v[128:129], v[128:129], v[106:107], v[106:107] op_sel:[0,0,0] op_sel_hi:[1,0,0]
  v_pk_fma_f32 v[130:131], v[130:131], v[106:107], v[106:107] op_sel:[0,0,0] op_sel_hi:[1,0,0]
  v_pk_fma_f32 v[132:133], v[132:133], v[106:107], v[106:107] op_sel:[0,0,0] op_sel_hi:[1,0,0]
  v_pk_fma_f32 v[134:135], v[134:135], v[106:107], v[106:107] op_sel:[0,0,0] op_sel_hi:[1,0,0]
  v_rcp_f32 v128, v128
  v_rcp_f32 v129, v129
  v_rcp_f32 v130, v130
  v_rcp_f32 v131, v131
  v_rcp_f32 v132, v132
  v_rcp_f32 v133, v133
  v_rcp_f32 v134, v134
  v_rcp_f32 v135, v135
  v_pk_mul_f32 v[128:129], v[248:249], v[128:129]
  v_pk_mul_f32 v[130:131], v[250:251], v[130:131]
  v_pk_mul_f32 v[132:133], v[252:253], v[132:133]
  v_pk_mul_f32 v[134:135], v[254:255], v[134:135]
  v_cvt_pk_bf16_f32 v140, v128, v129
  v_cvt_pk_bf16_f32 v141, v130, v131
  v_cvt_pk_bf16_f32 v142, v132, v133
  v_cvt_pk_bf16_f32 v143, v134, v135
  s_add_u32 s3, s6, 196608
  buffer_store_dwordx4 v[140:143], v14, s[44:47], s3 offen sc1
L_phase2:
  v_lshl_add_u32 v8, v2, 1, s83
  v_mov_b32 v11, s73
  s_waitcnt vmcnt(8) lgkmcnt(4)
  v_mfma_f32_32x32x16_bf16 v[160:175], v[48:51], v[16:19], 0
  ds_read_b64_tr_b16 v[64:65], v144 offset:8192
  ds_read_b64_tr_b16 v[66:67], v144 offset:9216
  ds_read_b64_tr_b16 v[68:69], v145 offset:8192
  v_mfma_f32_32x32x16_bf16 v[176:191], v[52:55], v[16:19], 0
  ds_read_b64_tr_b16 v[70:71], v145 offset:9216
  s_add_u32 s70, s70, 0x00001000
  buffer_load_dwordx4 v[16:19], v150, s[44:47], s70 offen offset:0 sc1
  buffer_load_ushort v128, v8, s[60:63], 0 offen
  s_waitcnt vmcnt(9) lgkmcnt(4)
  v_mfma_f32_32x32x16_bf16 v[176:191], v[60:63], v[20:23], v[176:191]
  ds_read_b64_tr_b16 v[48:49], v144 offset:12288
  ds_read_b64_tr_b16 v[50:51], v144 offset:13312
  ds_read_b64_tr_b16 v[52:53], v145 offset:12288
  v_mfma_f32_32x32x16_bf16 v[160:175], v[56:59], v[20:23], v[160:175]
  ds_read_b64_tr_b16 v[54:55], v145 offset:13312
  buffer_load_dwordx4 v[20:23], v150, s[44:47], s70 offen offset:1024 sc1
  s_waitcnt vmcnt(9) lgkmcnt(4)
  v_mfma_f32_32x32x16_bf16 v[160:175], v[64:67], v[24:27], v[160:175]
  ds_read_b64_tr_b16 v[56:57], v144 offset:16384
  ds_read_b64_tr_b16 v[58:59], v144 offset:17408
  ds_read_b64_tr_b16 v[60:61], v145 offset:16384
  v_mfma_f32_32x32x16_bf16 v[176:191], v[68:71], v[24:27], v[176:191]
  ds_read_b64_tr_b16 v[62:63], v145 offset:17408
  buffer_load_dwordx4 v[24:27], v150, s[44:47], s70 offen offset:2048 sc1
  s_waitcnt vmcnt(9) lgkmcnt(4)
  v_mfma_f32_32x32x16_bf16 v[176:191], v[52:55], v[28:31], v[176:191]
  ds_read_b64_tr_b16 v[64:65], v144 offset:20480
  ds_read_b64_tr_b16 v[66:67], v144 offset:21504
  ds_read_b64_tr_b16 v[68:69], v145 offset:20480
  v_mfma_f32_32x32x16_bf16 v[160:175], v[48:51], v[28:31], v[160:175]
  ds_read_b64_tr_b16 v[70:71], v145 offset:21504
  buffer_load_dwordx4 v[28:31], v150, s[44:47], s70 offen offset:3072 sc1
  s_add_u32 s81, s81, 2048
  buffer_load_dword v158, v0, s[44:47], s81 offen sc1
  s_waitcnt vmcnt(10) lgkmcnt(4)
  v_mfma_f32_32x32x16_bf16 v[160:175], v[56:59], v[32:35], v[160:175]
  ds_read_b64_tr_b16 v[48:49], v144 offset:24576
  ds_read_b64_tr_b16 v[50:51], v144 offset:25600
  ds_read_b64_tr_b16 v[52:53], v145 offset:24576
  v_mfma_f32_32x32x16_bf16 v[176:191], v[60:63], v[32:35], v[176:191]
  ds_read_b64_tr_b16 v[54:55], v145 offset:25600
  s_add_u32 s70, s70, 0x00001000
  buffer_load_dwordx4 v[32:35], v150, s[44:47], s70 offen offset:0 sc1
  s_waitcnt vmcnt(10) lgkmcnt(4)
  v_mfma_f32_32x32x16_bf16 v[176:191], v[68:71], v[36:39], v[176:191]
  ds_read_b64_tr_b16 v[56:57], v144 offset:28672
  ds_read_b64_tr_b16 v[58:59], v144 offset:29696
  ds_read_b64_tr_b16 v[60:61], v145 offset:28672
  v_mfma_f32_32x32x16_bf16 v[160:175], v[64:67], v[36:39], v[160:175]
  ds_read_b64_tr_b16 v[62:63], v145 offset:29696
  ds_read_b32 v159, v154 offset:0
  s_waitcnt vmcnt(7)
  buffer_store_dword v11, v7, s[44:47], s27 offen sc1
  buffer_load_dwordx4 v[36:39], v150, s[44:47], s70 offen offset:1024 sc1
  s_waitcnt lgkmcnt(5)
  v_mfma_f32_32x32x16_bf16 v[160:175], v[48:51], v[40:43], v[160:175]
  v_mov_b32 v9, 2
  ds_write_b32 v155, v9 offset:0
  s_waitcnt lgkmcnt(1)
  v_cmp_gt_u32 vcc, 2, v159
  s_cbranch_vccnz Llc_50
Llcok_51:
  ds_read_b64_tr_b16 v[64:65], v144 offset:32768
  ds_read_b64_tr_b16 v[66:67], v144 offset:33792
  ds_read_b64_tr_b16 v[68:69], v145 offset:32768
  v_mfma_f32_32x32x16_bf16 v[176:191], v[52:55], v[40:43], v[176:191]
  ds_read_b64_tr_b16 v[70:71], v145 offset:33792
  buffer_load_dwordx4 v[40:43], v150, s[44:47], s70 offen offset:2048 sc1
  v_mfma_f32_32x32x16_bf16 v[176:191], v[60:63], v[44:47], v[176:191]
  ds_read_b64_tr_b16 v[48:49], v144 offset:36864
  ds_read_b64_tr_b16 v[50:51], v144 offset:37888
  ds_read_b64_tr_b16 v[52:53], v145 offset:36864
  v_mfma_f32_32x32x16_bf16 v[160:175], v[56:59], v[44:47], v[160:175]
  ds_read_b64_tr_b16 v[54:55], v145 offset:37888
  s_waitcnt vmcnt(4)
  v_cmp_ne_u32 vcc, s73, v158
  s_cbranch_vccnz Lgc_53
Lgcok_54:
  buffer_load_dwordx4 v[44:47], v150, s[44:47], s70 offen offset:3072 sc1
  s_waitcnt lgkmcnt(4)
  v_mfma_f32_32x32x16_bf16 v[160:175], v[64:67], v[16:19], v[160:175]
  ds_read_b64_tr_b16 v[56:57], v144 offset:40960
  ds_read_b64_tr_b16 v[58:59], v144 offset:41984
  ds_read_b64_tr_b16 v[60:61], v145 offset:40960
  v_mfma_f32_32x32x16_bf16 v[176:191], v[68:71], v[16:19], v[176:191]
  ds_read_b64_tr_b16 v[62:63], v145 offset:41984
  s_add_u32 s70, s70, 0x00001000
  buffer_load_dwordx4 v[16:19], v150, s[44:47], s70 offen offset:0 sc1
  s_waitcnt lgkmcnt(4)
  v_mfma_f32_32x32x16_bf16 v[176:191], v[52:55], v[20:23], v[176:191]
  ds_read_b64_tr_b16 v[64:65], v144 offset:45056
  ds_read_b64_tr_b16 v[66:67], v144 offset:46080
  ds_read_b64_tr_b16 v[68:69], v145 offset:45056
  v_lshlrev_b32 v240, 16, v76
  v_and_b32 v241, 0xffff0000, v76
  v_mfma_f32_32x32x16_bf16 v[160:175], v[48:51], v[20:23], v[160:175]
  ds_read_b64_tr_b16 v[70:71], v145 offset:46080
  buffer_load_dwordx4 v[20:23], v150, s[44:47], s70 offen offset:1024 sc1
  v_lshlrev_b32 v242, 16, v77
  v_and_b32 v243, 0xffff0000, v77
  s_waitcnt lgkmcnt(4)
  v_mfma_f32_32x32x16_bf16 v[160:175], v[56:59], v[24:27], v[160:175]
  ds_read_b64_tr_b16 v[48:49], v144 offset:49152
  ds_read_b64_tr_b16 v[50:51], v144 offset:50176
  ds_read_b64_tr_b16 v[52:53], v145 offset:49152
  v_lshlrev_b32 v244, 16, v78
  v_and_b32 v245, 0xffff0000, v78
  v_mfma_f32_32x32x16_bf16 v[176:191], v[60:63], v[24:27], v[176:191]
  ds_read_b64_tr_b16 v[54:55], v145 offset:50176
  buffer_load_dwordx4 v[24:27], v150, s[44:47], s70 offen offset:2048 sc1
  v_lshlrev_b32 v246, 16, v79
  v_and_b32 v247, 0xffff0000, v79
  s_waitcnt lgkmcnt(4)
  v_mfma_f32_32x32x16_bf16 v[176:191], v[68:71], v[28:31], v[176:191]
  ds_read_b64_tr_b16 v[56:57], v144 offset:53248
  ds_read_b64_tr_b16 v[58:59], v144 offset:54272
  ds_read_b64_tr_b16 v[60:61], v145 offset:53248
  v_lshlrev_b32 v248, 16, v80
  v_and_b32 v249, 0xffff0000, v80
  v_mfma_f32_32x32x16_bf16 v[160:175], v[64:67], v[28:31], v[160:175]
  ds_read_b64_tr_b16 v[62:63], v145 offset:54272
  buffer_load_dwordx4 v[28:31], v150, s[44:47], s70 offen offset:3072 sc1
  v_lshlrev_b32 v250, 16, v81
  v_and_b32 v251, 0xffff0000, v81
  s_waitcnt vmcnt(8) lgkmcnt(4)
  v_mfma_f32_32x32x16_bf16 v[160:175], v[48:51], v[32:35], v[160:175]
  ds_read_b64_tr_b16 v[64:65], v144 offset:57344
  ds_read_b64_tr_b16 v[66:67], v144 offset:58368
  ds_read_b64_tr_b16 v[68:69], v145 offset:57344
  v_lshlrev_b32 v252, 16, v82
  v_and_b32 v253, 0xffff0000, v82
  v_mfma_f32_32x32x16_bf16 v[176:191], v[52:55], v[32:35], v[176:191]
  ds_read_b64_tr_b16 v[70:71], v145 offset:58368
  s_add_u32 s70, s70, 0x00001000
  buffer_load_dwordx4 v[32:35], v150, s[44:47], s70 offen offset:0 sc1
  v_lshlrev_b32 v254, 16, v83
  v_and_b32 v255, 0xffff0000, v83
  s_waitcnt vmcnt(7) lgkmcnt(4)
  v_mfma_f32_32x32x16_bf16 v[176:191], v[60:63], v[36:39], v[176:191]
  ds_read_b64_tr_b16 v[48:49], v144 offset:61440
  ds_read_b64_tr_b16 v[50:51], v144 offset:62464
  ds_read_b64_tr_b16 v[52:53], v145 offset:61440
  v_cmp_gt_u32 vcc, 32, v1
  v_mov_b32 v12, 0x3f80
  s_nop 0
  v_cndmask_b32 v132, 0, v12, vcc
  v_mfma_f32_32x32x16_bf16 v[160:175], v[56:59], v[36:39], v[160:175]
  ds_read_b64_tr_b16 v[54:55], v145 offset:62464
  buffer_load_dwordx4 v[36:39], v150, s[44:47], s70 offen offset:1024 sc1
  v_mov_b32 v129, 0
  v_mov_b32 v130, 0
  s_waitcnt vmcnt(7) lgkmcnt(4)
  v_mfma_f32_32x32x16_bf16 v[160:175], v[64:67], v[40:43], v[160:175]
  ds_read_b64_tr_b16 v[56:57], v146 offset:0
  ds_read_b64_tr_b16 v[58:59], v146 offset:1024
  ds_read_b64_tr_b16 v[60:61], v147 offset:0
  v_mov_b32 v131, 0
  v_mov_b32 v133, 0
  v_mfma_f32_32x32x16_bf16 v[176:191], v[68:71], v[40:43], v[176:191]
  ds_read_b64_tr_b16 v[62:63], v147 offset:1024
  buffer_load_dwordx4 v[40:43], v150, s[44:47], s70 offen offset:2048 sc1
  v_mov_b32 v134, 0
  v_mov_b32 v135, 0
  s_waitcnt vmcnt(7) lgkmcnt(4)
  v_mfma_f32_32x32x16_bf16 v[176:191], v[52:55], v[44:47], v[176:191]
  ds_read_b64_tr_b16 v[64:65], v146 offset:4096
  ds_read_b64_tr_b16 v[66:67], v146 offset:5120
  ds_read_b64_tr_b16 v[68:69], v147 offset:4096
  v_mfma_f32_32x32x16_bf16 v[160:175], v[48:51], v[44:47], v[160:175]
  ds_read_b64_tr_b16 v[70:71], v147 offset:5120
  buffer_load_dwordx4 v[44:47], v150, s[44:47], s70 offen offset:3072 sc1
  s_waitcnt vmcnt(7) lgkmcnt(4)
  v_mfma_f32_32x32x16_bf16 v[160:175], v[56:59], v[16:19], v[160:175]
  v_mov_b32 v9, 3
  ds_write_b32 v155, v9 offset:0
  ds_read_b64_tr_b16 v[48:49], v146 offset:8192
  ds_read_b64_tr_b16 v[50:51], v146 offset:9216
  ds_read_b64_tr_b16 v[52:53], v147 offset:8192
  s_nop 0
  v_mfma_f32_32x32x16_bf16 v[176:191], v[60:63], v[16:19], v[176:191]
  ds_read_b64_tr_b16 v[54:55], v147 offset:9216
  s_add_u32 s70, s70, 0x00001000
  buffer_load_dwordx4 v[16:19], v150, s[44:47], s70 offen offset:0 sc1
  v_mfma_f32_32x32x16_bf16 v[160:175], v[128:131], v[132:135], v[160:175]
  s_waitcnt vmcnt(7) lgkmcnt(5)
  v_mfma_f32_32x32x16_bf16 v[176:191], v[68:71], v[20:23], v[176:191]
  ds_read_b64_tr_b16 v[56:57], v146 offset:12288
  ds_read_b64_tr_b16 v[58:59], v146 offset:13312
  ds_read_b64_tr_b16 v[60:61], v147 offset:12288
  v_mfma_f32_32x32x16_bf16 v[160:175], v[64:67], v[20:23], v[160:175]
  ds_read_b64_tr_b16 v[62:63], v147 offset:13312
  buffer_load_dwordx4 v[20:23], v150, s[44:47], s70 offen offset:1024 sc1
  s_add_u32 s81, s81, 2048
  buffer_load_dword v158, v0, s[44:47], s81 offen sc1
  s_waitcnt vmcnt(8) lgkmcnt(4)
  v_mfma_f32_32x32x16_bf16 v[160:175], v[48:51], v[24:27], v[160:175]
  ds_read_b64_tr_b16 v[64:65], v146 offset:16384
  ds_read_b64_tr_b16 v[66:67], v146 offset:17408
  ds_read_b64_tr_b16 v[68:69], v147 offset:16384
  v_mfma_f32_32x32x16_bf16 v[176:191], v[52:55], v[24:27], v[176:191]
  ds_read_b64_tr_b16 v[70:71], v147 offset:17408
  buffer_load_dwordx4 v[24:27], v150, s[44:47], s70 offen offset:2048 sc1
  s_waitcnt vmcnt(8) lgkmcnt(4)
  v_mfma_f32_32x32x16_bf16 v[176:191], v[60:63], v[28:31], v[176:191]
  ds_read_b64_tr_b16 v[48:49], v146 offset:20480
  ds_read_b64_tr_b16 v[50:51], v146 offset:21504
  ds_read_b64_tr_b16 v[52:53], v147 offset:20480
  v_mfma_f32_32x32x16_bf16 v[160:175], v[56:59], v[28:31], v[160:175]
  ds_read_b64_tr_b16 v[54:55], v147 offset:21504
  buffer_load_dwordx4 v[28:31], v150, s[44:47], s70 offen offset:3072 sc1
  s_waitcnt vmcnt(8) lgkmcnt(4)
  v_mfma_f32_32x32x16_bf16 v[160:175], v[64:67], v[32:35], v[160:175]
  v_mov_b32 v9, 4
  ds_write_b32 v155, v9 offset:0
  ds_read_b64_tr_b16 v[56:57], v146 offset:24576
  ds_read_b64_tr_b16 v[58:59], v146 offset:25600
  ds_read_b64_tr_b16 v[60:61], v147 offset:24576
  v_mfma_f32_32x32x16_bf16 v[176:191], v[68:71], v[32:35], v[176:191]
  ds_read_b64_tr_b16 v[62:63], v147 offset:25600
  ds_read_b32 v159, v154 offset:0
  s_add_u32 s70, s70, 0x00001000
  buffer_load_dwordx4 v[32:35], v150, s[44:47], s70 offen offset:0 sc1
  s_waitcnt vmcnt(8) lgkmcnt(6)
  v_mfma_f32_32x32x16_bf16 v[176:191], v[52:55], v[36:39], v[176:191]
  s_waitcnt lgkmcnt(0)
  v_cmp_gt_u32 vcc, 3, v159
  s_cbranch_vccnz Llc_57
Llcok_58:
  ds_read_b64_tr_b16 v[64:65], v146 offset:28672
  ds_read_b64_tr_b16 v[66:67], v146 offset:29696
  ds_read_b64_tr_b16 v[68:69], v147 offset:28672
  v_mfma_f32_32x32x16_bf16 v[160:175], v[48:51], v[36:39], v[160:175]
  ds_read_b64_tr_b16 v[70:71], v147 offset:29696
  s_waitcnt vmcnt(3)
  v_cmp_ne_u32 vcc, s73, v158
  s_cbranch_vccnz Lgc_60
Lgcok_61:
  buffer_load_dwordx4 v[36:39], v150, s[44:47], s70 offen offset:1024 sc1
  v_mfma_f32_32x32x16_bf16 v[160:175], v[56:59], v[40:43], v[160:175]
  ds_read_b64_tr_b16 v[48:49], v146 offset:32768
  ds_read_b64_tr_b16 v[50:51], v146 offset:33792
  ds_read_b64_tr_b16 v[52:53], v147 offset:32768
  v_mfma_f32_32x32x16_bf16 v[176:191], v[60:63], v[40:43], v[176:191]
  ds_read_b64_tr_b16 v[54:55], v147 offset:33792
  buffer_load_dwordx4 v[40:43], v150, s[44:47], s70 offen offset:2048 sc1
  s_waitcnt lgkmcnt(4)
  v_mfma_f32_32x32x16_bf16 v[176:191], v[68:71], v[44:47], v[176:191]
  ds_read_b64_tr_b16 v[56:57], v146 offset:36864
  ds_read_b64_tr_b16 v[58:59], v146 offset:37888
  ds_read_b64_tr_b16 v[60:61], v147 offset:36864
  v_mfma_f32_32x32x16_bf16 v[160:175], v[64:67], v[44:47], v[160:175]
  ds_read_b64_tr_b16 v[62:63], v147 offset:37888
  buffer_load_dwordx4 v[44:47], v150, s[44:47], s70 offen offset:3072 sc1
  s_waitcnt lgkmcnt(4)
  v_mfma_f32_32x32x16_bf16 v[160:175], v[48:51], v[16:19], v[160:175]
  ds_read_b64_tr_b16 v[64:65], v146 offset:40960
  ds_read_b64_tr_b16 v[66:67], v146 offset:41984
  ds_read_b64_tr_b16 v[68:69], v147 offset:40960
  v_mfma_f32_32x32x16_bf16 v[176:191], v[52:55], v[16:19], v[176:191]
  ds_read_b64_tr_b16 v[70:71], v147 offset:41984
  s_add_u32 s70, s70, 0x00001000
  buffer_load_dwordx4 v[16:19], v150, s[44:47], s70 offen offset:0 sc1
  s_waitcnt lgkmcnt(4)
  v_mfma_f32_32x32x16_bf16 v[176:191], v[60:63], v[20:23], v[176:191]
  ds_read_b64_tr_b16 v[48:49], v146 offset:45056
  ds_read_b64_tr_b16 v[50:51], v146 offset:46080
  ds_read_b64_tr_b16 v[52:53], v147 offset:45056
  v_mfma_f32_32x32x16_bf16 v[160:175], v[56:59], v[20:23], v[160:175]
  ds_read_b64_tr_b16 v[54:55], v147 offset:46080
  buffer_load_dwordx4 v[20:23], v150, s[44:47], s70 offen offset:1024 sc1
  s_waitcnt vmcnt(7) lgkmcnt(4)
  v_mfma_f32_32x32x16_bf16 v[160:175], v[64:67], v[24:27], v[160:175]
  ds_read_b64_tr_b16 v[56:57], v146 offset:49152
  ds_read_b64_tr_b16 v[58:59], v146 offset:50176
  ds_read_b64_tr_b16 v[60:61], v147 offset:49152
  v_mfma_f32_32x32x16_bf16 v[176:191], v[68:71], v[24:27], v[176:191]
  ds_read_b64_tr_b16 v[62:63], v147 offset:50176
  buffer_load_dwordx4 v[24:27], v150, s[44:47], s70 offen offset:2048 sc1
  s_waitcnt vmcnt(7) lgkmcnt(4)
  v_mfma_f32_32x32x16_bf16 v[176:191], v[52:55], v[28:31], v[176:191]
  ds_read_b64_tr_b16 v[64:65], v146 offset:53248
  ds_read_b64_tr_b16 v[66:67], v146 offset:54272
  ds_read_b64_tr_b16 v[68:69], v147 offset:53248
  v_mfma_f32_32x32x16_bf16 v[160:175], v[48:51], v[28:31], v[160:175]
  ds_read_b64_tr_b16 v[70:71], v147 offset:54272
  buffer_load_dwordx4 v[28:31], v150, s[44:47], s70 offen offset:3072 sc1
  s_waitcnt vmcnt(7) lgkmcnt(4)
  v_mfma_f32_32x32x16_bf16 v[160:175], v[56:59], v[32:35], v[160:175]
  ds_read_b64_tr_b16 v[48:49], v146 offset:57344
  ds_read_b64_tr_b16 v[50:51], v146 offset:58368
  ds_read_b64_tr_b16 v[52:53], v147 offset:57344
  v_mfma_f32_32x32x16_bf16 v[176:191], v[60:63], v[32:35], v[176:191]
  ds_read_b64_tr_b16 v[54:55], v147 offset:58368
  s_add_u32 s70, s70, 0x00001000
  buffer_load_dwordx4 v[32:35], v150, s[44:47], s70 offen offset:0 sc1
  s_waitcnt vmcnt(7) lgkmcnt(4)
  v_mfma_f32_32x32x16_bf16 v[176:191], v[68:71], v[36:39], v[176:191]
  ds_read_b64_tr_b16 v[56:57], v146 offset:61440
  ds_read_b64_tr_b16 v[58:59], v146 offset:62464
  ds_read_b64_tr_b16 v[60:61], v147 offset:61440
  v_mfma_f32_32x32x16_bf16 v[160:175], v[64:67], v[36:39], v[160:175]
  ds_read_b64_tr_b16 v[62:63], v147 offset:62464
  buffer_load_dwordx4 v[36:39], v150, s[44:47], s70 offen offset:1024 sc1
  s_waitcnt vmcnt(7) lgkmcnt(4)
  v_mfma_f32_32x32x16_bf16 v[160:175], v[48:51], v[40:43], v[160:175]
  v_mov_b32 v9, 5
  ds_write_b32 v155, v9 offset:0
  ds_read_b64_tr_b16 v[64:65], v148 offset:0
  ds_read_b64_tr_b16 v[66:67], v148 offset:1024
  ds_read_b64_tr_b16 v[68:69], v149 offset:0
  v_mfma_f32_32x32x16_bf16 v[176:191], v[52:55], v[40:43], v[176:191]
  ds_read_b64_tr_b16 v[70:71], v149 offset:1024
  buffer_load_dwordx4 v[40:43], v150, s[44:47], s70 offen offset:2048 sc1
  s_waitcnt vmcnt(7) lgkmcnt(5)
  v_mfma_f32_32x32x16_bf16 v[176:191], v[60:63], v[44:47], v[176:191]
  ds_read_b64_tr_b16 v[48:49], v148 offset:4096
  ds_read_b64_tr_b16 v[50:51], v148 offset:5120
  ds_read_b64_tr_b16 v[52:53], v149 offset:4096
  v_mfma_f32_32x32x16_bf16 v[160:175], v[56:59], v[44:47], v[160:175]
  ds_read_b64_tr_b16 v[54:55], v149 offset:5120
  buffer_load_dwordx4 v[44:47], v150, s[44:47], s70 offen offset:3072 sc1
  buffer_load_dword v158, v0, s[44:47], s82 offen sc1
  s_waitcnt vmcnt(8) lgkmcnt(4)
  v_mfma_f32_32x32x16_bf16 v[160:175], v[64:67], v[16:19], v[160:175]
  ds_read_b64_tr_b16 v[56:57], v148 offset:8192
  ds_read_b64_tr_b16 v[58:59], v148 offset:9216
  ds_read_b64_tr_b16 v[60:61], v149 offset:8192
  v_mfma_f32_32x32x16_bf16 v[176:191], v[68:71], v[16:19], v[176:191]
  ds_read_b64_tr_b16 v[62:63], v149 offset:9216
  s_add_u32 s70, s70, 0x00001000
  buffer_load_dwordx4 v[16:19], v150, s[44:47], s70 offen offset:0 sc1
  s_waitcnt vmcnt(8) lgkmcnt(4)
  v_mfma_f32_32x32x16_bf16 v[176:191], v[52:55], v[20:23], v[176:191]
  ds_read_b64_tr_b16 v[64:65], v148 offset:12288
  ds_read_b64_tr_b16 v[66:67], v148 offset:13312
  ds_read_b64_tr_b16 v[68:69], v149 offset:12288
  v_mfma_f32_32x32x16_bf16 v[160:175], v[48:51], v[20:23], v[160:175]
  ds_read_b64_tr_b16 v[70:71], v149 offset:13312
  buffer_load_dwordx4 v[20:23], v150, s[44:47], s70 offen offset:1024 sc1
  s_waitcnt vmcnt(8) lgkmcnt(4)
  v_mfma_f32_32x32x16_bf16 v[160:175], v[56:59], v[24:27], v[160:175]
  ds_read_b64_tr_b16 v[48:49], v148 offset:16384
  ds_read_b64_tr_b16 v[50:51], v148 offset:17408
  ds_read_b64_tr_b16 v[52:53], v149 offset:16384
  v_mfma_f32_32x32x16_bf16 v[176:191], v[60:63], v[24:27], v[176:191]
  ds_read_b64_tr_b16 v[54:55], v149 offset:17408
  buffer_load_dwordx4 v[24:27], v150, s[44:47], s70 offen offset:2048 sc1
  s_waitcnt vmcnt(8) lgkmcnt(4)
  v_mfma_f32_32x32x16_bf16 v[176:191], v[68:71], v[28:31], v[176:191]
  ds_read_b64_tr_b16 v[56:57], v148 offset:20480
  ds_read_b64_tr_b16 v[58:59], v148 offset:21504
  ds_read_b64_tr_b16 v[60:61], v149 offset:20480
  v_mfma_f32_32x32x16_bf16 v[160:175], v[64:67], v[28:31], v[160:175]
  ds_read_b64_tr_b16 v[62:63], v149 offset:21504
  ds_read_b32 v159, v154 offset:0
  s_waitcnt vmcnt(3)
  v_cmp_ne_u32 vcc, s73, v158
  s_cbranch_vccnz Lgc_64
Lgcok_65:
  buffer_load_dwordx4 v[28:31], v150, s[44:47], s70 offen offset:3072 sc1
  s_waitcnt lgkmcnt(5)
  v_mfma_f32_32x32x16_bf16 v[160:175], v[48:51], v[32:35], v[160:175]
  s_waitcnt lgkmcnt(0)
  v_cmp_gt_u32 vcc, 4, v159
  s_cbranch_vccnz Llc_68
Llcok_69:
  ds_read_b64_tr_b16 v[64:65], v144 offset:0
  ds_read_b64_tr_b16 v[66:67], v144 offset:1024
  ds_read_b64_tr_b16 v[68:69], v145 offset:0
  v_mfma_f32_32x32x16_bf16 v[176:191], v[52:55], v[32:35], v[176:191]
  ds_read_b64_tr_b16 v[70:71], v145 offset:1024
  s_add_u32 s70, s70, 0x00001000
  buffer_load_dwordx4 v[32:35], v150, s[44:47], s70 offen offset:0 sc1
  v_mfma_f32_32x32x16_bf16 v[176:191], v[60:63], v[36:39], v[176:191]
  ds_read_b64_tr_b16 v[48:49], v144 offset:4096
  ds_read_b64_tr_b16 v[50:51], v144 offset:5120
  ds_read_b64_tr_b16 v[52:53], v145 offset:4096
  v_mfma_f32_32x32x16_bf16 v[160:175], v[56:59], v[36:39], v[160:175]
  ds_read_b64_tr_b16 v[54:55], v145 offset:5120
  buffer_load_dwordx4 v[36:39], v150, s[44:47], s70 offen offset:1024 sc1
  s_waitcnt lgkmcnt(4)
  v_mfma_f32_32x32x16_bf16 v[160:175], v[64:67], v[40:43], v[160:175]
  ds_read_b64_tr_b16 v[56:57], v144 offset:8192
  ds_read_b64_tr_b16 v[58:59], v144 offset:9216
  ds_read_b64_tr_b16 v[60:61], v145 offset:8192
  v_mfma_f32_32x32x16_bf16 v[176:191], v[68:71], v[40:43], v[176:191]
  ds_read_b64_tr_b16 v[62:63], v145 offset:9216
  buffer_load_dwordx4 v[40:43], v150, s[44:47], s70 offen offset:2048 sc1
  s_waitcnt lgkmcnt(4)
  v_mfma_f32_32x32x16_bf16 v[176:191], v[52:55], v[44:47], v[176:191]
  ds_read_b64_tr_b16 v[64:65], v144 offset:12288
  ds_read_b64_tr_b16 v[66:67], v144 offset:13312
  ds_read_b64_tr_b16 v[68:69], v145 offset:12288
  v_mfma_f32_32x32x16_bf16 v[160:175], v[48:51], v[44:47], v[160:175]
  ds_read_b64_tr_b16 v[70:71], v145 offset:13312
  buffer_load_dwordx4 v[44:47], v150, s[44:47], s70 offen offset:3072 sc1
  s_waitcnt vmcnt(7) lgkmcnt(4)
  v_mfma_f32_32x32x16_bf16 v[160:175], v[56:59], v[16:19], v[160:175]
  ds_read_b64_tr_b16 v[48:49], v144 offset:16384
  ds_read_b64_tr_b16 v[50:51], v144 offset:17408
  ds_read_b64_tr_b16 v[52:53], v145 offset:16384
  v_mfma_f32_32x32x16_bf16 v[176:191], v[60:63], v[16:19], v[176:191]
  ds_read_b64_tr_b16 v[54:55], v145 offset:17408
  s_add_u32 s70, s70, 0x00001000
  buffer_load_dwordx4 v[16:19], v150, s[44:47], s70 offen offset:0 sc1
  s_waitcnt vmcnt(7) lgkmcnt(4)
  v_mfma_f32_32x32x16_bf16 v[176:191], v[68:71], v[20:23], v[176:191]
  ds_read_b64_tr_b16 v[56:57], v144 offset:20480
  ds_read_b64_tr_b16 v[58:59], v144 offset:21504
  ds_read_b64_tr_b16 v[60:61], v145 offset:20480
  v_mfma_f32_32x32x16_bf16 v[160:175], v[64:67], v[20:23], v[160:175]
  ds_read_b64_tr_b16 v[62:63], v145 offset:21504
  buffer_load_dwordx4 v[20:23], v150, s[44:47], s70 offen offset:1024 sc1
  s_waitcnt vmcnt(7) lgkmcnt(4)
  v_mfma_f32_32x32x16_bf16 v[160:175], v[48:51], v[24:27], v[160:175]
  ds_read_b64_tr_b16 v[64:65], v144 offset:24576
  ds_read_b64_tr_b16 v[66:67], v144 offset:25600
  ds_read_b64_tr_b16 v[68:69], v145 offset:24576
  v_mfma_f32_32x32x16_bf16 v[176:191], v[52:55], v[24:27], v[176:191]
  ds_read_b64_tr_b16 v[70:71], v145 offset:25600
  ds_read_b32 v159, v154 offset:0
  buffer_load_dwordx4 v[24:27], v150, s[44:47], s70 offen offset:2048 sc1
  s_waitcnt vmcnt(7) lgkmcnt(5)
  v_mfma_f32_32x32x16_bf16 v[208:223], v[60:63], v[28:31], 0
  s_waitcnt lgkmcnt(0)
  v_cmp_gt_u32 vcc, 5, v159
  s_cbranch_vccnz Llc_71
Llcok_72:
  ds_read_b64_tr_b16 v[48:49], v144 offset:28672
  ds_read_b64_tr_b16 v[50:51], v144 offset:29696
  ds_read_b64_tr_b16 v[52:53], v145 offset:28672
  v_mfma_f32_32x32x16_bf16 v[192:207], v[56:59], v[28:31], 0
  ds_read_b64_tr_b16 v[54:55], v145 offset:29696
  ds_read_b32 v159, v154 offset:16
  buffer_load_dwordx4 v[28:31], v150, s[44:47], s70 offen offset:3072 sc1
  s_waitcnt vmcnt(7)
  v_mfma_f32_32x32x16_bf16 v[192:207], v[64:67], v[32:35], v[192:207]
  s_waitcnt lgkmcnt(0)
  v_cmp_gt_u32 vcc, 5, v159
  s_cbranch_vccnz Llc_74
Llcok_75:
  ds_write_b128 v151, v[176:179] offset:0
  ds_write_b128 v151, v[180:183] offset:1024
  ds_write_b128 v151, v[184:187] offset:2048
  ds_write_b128 v151, v[188:191] offset:3072
  v_mov_b32 v9, 1
  ds_write_b32 v157, v9 offset:8
  ds_read_b64_tr_b16 v[56:57], v144 offset:32768
  ds_read_b64_tr_b16 v[58:59], v144 offset:33792
  ds_read_b64_tr_b16 v[60:61], v145 offset:32768
  v_mfma_f32_32x32x16_bf16 v[208:223], v[68:71], v[32:35], v[208:223]
  ds_read_b64_tr_b16 v[62:63], v145 offset:33792
  s_add_u32 s70, s70, 0x00001000
  buffer_load_dwordx4 v[32:35], v150, s[44:47], s70 offen offset:0 sc1
  s_waitcnt vmcnt(7)
  v_mfma_f32_32x32x16_bf16 v[208:223], v[52:55], v[36:39], v[208:223]
  ds_read_b64_tr_b16 v[64:65], v144 offset:36864
  ds_read_b64_tr_b16 v[66:67], v144 offset:37888
  ds_read_b64_tr_b16 v[68:69], v145 offset:36864
  v_mfma_f32_32x32x16_bf16 v[192:207], v[48:51], v[36:39], v[192:207]
  ds_read_b64_tr_b16 v[70:71], v145 offset:37888
  ds_read_b32 v159, v156 offset:8
  ds_read_b128 v[96:99], v152 offset:0
  ds_read_b128 v[100:103], v152 offset:1024
  ds_read_b128 v[104:107], v152 offset:2048
  ds_read_b128 v[108:111], v152 offset:3072
  buffer_load_dwordx4 v[36:39], v150, s[44:47], s70 offen offset:1024 sc1
  s_waitcnt vmcnt(7) lgkmcnt(9)
  v_mfma_f32_32x32x16_bf16 v[192:207], v[56:59], v[40:43], v[192:207]
  ds_read_b64_tr_b16 v[48:49], v144 offset:40960
  ds_read_b64_tr_b16 v[50:51], v144 offset:41984
  ds_read_b64_tr_b16 v[52:53], v145 offset:40960
  v_mfma_f32_32x32x16_bf16 v[208:223], v[60:63], v[40:43], v[208:223]
  ds_read_b64_tr_b16 v[54:55], v145 offset:41984
  buffer_load_dwordx4 v[40:43], v150, s[44:47], s70 offen offset:2048 sc1
  s_waitcnt vmcnt(7) lgkmcnt(9)
  v_mfma_f32_32x32x16_bf16 v[208:223], v[68:71], v[44:47], v[208:223]
  s_waitcnt lgkmcnt(4)
  v_cmp_gt_u32 vcc, 1, v159
  s_cbranch_vccnz Llc_77
Llcok_78:
  ds_read_b64_tr_b16 v[56:57], v144 offset:45056
  ds_read_b64_tr_b16 v[58:59], v144 offset:46080
  ds_read_b64_tr_b16 v[60:61], v145 offset:45056
  v_add_f32 v112, v96, v160
  v_add_f32 v113, v97, v161
  v_add_f32 v114, v98, v162
  v_add_f32 v115, v99, v163
  v_mfma_f32_32x32x16_bf16 v[192:207], v[64:67], v[44:47], v[192:207]
  ds_read_b64_tr_b16 v[62:63], v145 offset:46080
  buffer_load_dwordx4 v[44:47], v150, s[44:47], s70 offen offset:3072 sc1
  v_add_f32 v116, v100, v164
  v_add_f32 v117, v101, v165
  v_add_f32 v118, v102, v166
  v_add_f32 v119, v103, v167
  s_waitcnt vmcnt(7) lgkmcnt(4)
  v_mfma_f32_32x32x16_bf16 v[192:207], v[48:51], v[16:19], v[192:207]
  ds_read_b64_tr_b16 v[64:65], v144 offset:49152
  ds_read_b64_tr_b16 v[66:67], v144 offset:50176
  ds_read_b64_tr_b16 v[68:69], v145 offset:49152
  v_mul_f32 v96, 0xbfb8aa3b, v112
  v_mul_f32 v97, 0xbfb8aa3b, v113
  v_mul_f32 v98, 0xbfb8aa3b, v114
  v_mul_f32 v99, 0xbfb8aa3b, v115
  v_mfma_f32_32x32x16_bf16 v[208:223], v[52:55], v[16:19], v[208:223]
  ds_read_b64_tr_b16 v[70:71], v145 offset:50176
  s_add_u32 s70, s70, 0x00001000
  buffer_load_dwordx4 v[16:19], v150, s[44:47], s70 offen offset:0 sc1
  v_mul_f32 v100, 0xbfb8aa3b, v116
  v_mul_f32 v101, 0xbfb8aa3b, v117
  v_mul_f32 v102, 0xbfb8aa3b, v118
  v_mul_f32 v103, 0xbfb8aa3b, v119
  s_waitcnt vmcnt(7) lgkmcnt(4)
  v_mfma_f32_32x32x16_bf16 v[208:223], v[60:63], v[20:23], v[208:223]
  ds_read_b64_tr_b16 v[48:49], v144 offset:53248
  ds_read_b64_tr_b16 v[50:51], v144 offset:54272
  ds_read_b64_tr_b16 v[52:53], v145 offset:53248
  v_exp_f32 v96, v96
  v_exp_f32 v97, v97
  v_exp_f32 v98, v98
  v_exp_f32 v99, v99
  v_mfma_f32_32x32x16_bf16 v[192:207], v[56:59], v[20:23], v[192:207]
  ds_read_b64_tr_b16 v[54:55], v145 offset:54272
  buffer_load_dwordx4 v[20:23], v150, s[44:47], s70 offen offset:1024 sc1
  v_exp_f32 v100, v100
  v_exp_f32 v101, v101
  v_exp_f32 v102, v102
  v_exp_f32 v103, v103
  s_waitcnt vmcnt(7) lgkmcnt(4)
  v_mfma_f32_32x32x16_bf16 v[192:207], v[64:67], v[24:27], v[192:207]
  ds_read_b64_tr_b16 v[56:57], v144 offset:57344
  ds_read_b64_tr_b16 v[58:59], v144 offset:58368
  ds_read_b64_tr_b16 v[60:61], v145 offset:57344
  v_add_f32 v96, 1.0, v96
  v_add_f32 v97, 1.0, v97
  v_add_f32 v98, 1.0, v98
  v_add_f32 v99, 1.0, v99
  v_mfma_f32_32x32x16_bf16 v[208:223], v[68:71], v[24:27], v[208:223]
  ds_read_b64_tr_b16 v[62:63], v145 offset:58368
  buffer_load_dwordx4 v[24:27], v150, s[44:47], s70 offen offset:2048 sc1
  v_add_f32 v100, 1.0, v100
  v_add_f32 v101, 1.0, v101
  v_add_f32 v102, 1.0, v102
  v_add_f32 v103, 1.0, v103
  s_waitcnt vmcnt(7) lgkmcnt(4)
  v_mfma_f32_32x32x16_bf16 v[208:223], v[52:55], v[28:31], v[208:223]
  ds_read_b64_tr_b16 v[64:65], v144 offset:61440
  ds_read_b64_tr_b16 v[66:67], v144 offset:62464
  ds_read_b64_tr_b16 v[68:69], v145 offset:61440
  v_rcp_f32 v96, v96
  v_rcp_f32 v97, v97
  v_rcp_f32 v98, v98
  v_rcp_f32 v99, v99
  v_mfma_f32_32x32x16_bf16 v[192:207], v[48:51], v[28:31], v[192:207]
  ds_read_b64_tr_b16 v[70:71], v145 offset:62464
  v_rcp_f32 v100, v100
  v_rcp_f32 v101, v101
  v_rcp_f32 v102, v102
  v_rcp_f32 v103, v103
  s_waitcnt vmcnt(6) lgkmcnt(4)
  v_mfma_f32_32x32x16_bf16 v[192:207], v[56:59], v[32:35], v[192:207]
  ds_read_b64_tr_b16 v[48:49], v146 offset:0
  ds_read_b64_tr_b16 v[50:51], v146 offset:1024
  ds_read_b64_tr_b16 v[52:53], v147 offset:0
  v_mul_f32 v112, v112, v96
  v_mul_f32 v113, v113, v97
  v_mul_f32 v114, v114, v98
  v_mul_f32 v115, v115, v99
  v_mfma_f32_32x32x16_bf16 v[208:223], v[60:63], v[32:35], v[208:223]
  ds_read_b64_tr_b16 v[54:55], v147 offset:1024
  ds_read_b32 v159, v154 offset:0
  v_mul_f32 v116, v116, v100
  v_mul_f32 v117, v117, v101
  v_mul_f32 v118, v118, v102
  v_mul_f32 v119, v119, v103
  s_waitcnt vmcnt(5) lgkmcnt(5)
  v_mfma_f32_32x32x16_bf16 v[208:223], v[68:71], v[36:39], v[208:223]
  s_waitcnt lgkmcnt(0)
  v_cmp_gt_u32 vcc, 6, v159
  s_cbranch_vccnz Llc_80
Llcok_81:
  ds_read_b64_tr_b16 v[56:57], v146 offset:4096
  ds_read_b64_tr_b16 v[58:59], v146 offset:5120
  ds_read_b64_tr_b16 v[60:61], v147 offset:4096
  v_add_f32 v120, v104, v168
  v_add_f32 v121, v105, v169
  v_add_f32 v122, v106, v170
  v_add_f32 v123, v107, v171
  v_mfma_f32_32x32x16_bf16 v[192:207], v[64:67], v[36:39], v[192:207]
  ds_read_b64_tr_b16 v[62:63], v147 offset:5120
  v_add_f32 v124, v108, v172
  v_add_f32 v125, v109, v173
  v_add_f32 v126, v110, v174
  v_add_f32 v127, v111, v175
  s_waitcnt vmcnt(4)
  v_mfma_f32_32x32x16_bf16 v[192:207], v[48:51], v[40:43], v[192:207]
  ds_read_b64_tr_b16 v[64:65], v146 offset:8192
  ds_read_b64_tr_b16 v[66:67], v146 offset:9216
  ds_read_b64_tr_b16 v[68:69], v147 offset:8192
  v_mul_f32 v104, 0xbfb8aa3b, v120
  v_mul_f32 v105, 0xbfb8aa3b, v121
  v_mul_f32 v106, 0xbfb8aa3b, v122
  v_mul_f32 v107, 0xbfb8aa3b, v123
  v_mfma_f32_32x32x16_bf16 v[208:223], v[52:55], v[40:43], v[208:223]
  ds_read_b64_tr_b16 v[70:71], v147 offset:9216
  v_mul_f32 v108, 0xbfb8aa3b, v124
  v_mul_f32 v109, 0xbfb8aa3b, v125
  v_mul_f32 v110, 0xbfb8aa3b, v126
  v_mul_f32 v111, 0xbfb8aa3b, v127
  s_waitcnt vmcnt(3) lgkmcnt(4)
  v_mfma_f32_32x32x16_bf16 v[208:223], v[60:63], v[44:47], v[208:223]
  ds_read_b64_tr_b16 v[48:49], v146 offset:12288
  ds_read_b64_tr_b16 v[50:51], v146 offset:13312
  ds_read_b64_tr_b16 v[52:53], v147 offset:12288
  v_exp_f32 v104, v104
  v_exp_f32 v105, v105
  v_exp_f32 v106, v106
  v_exp_f32 v107, v107
  v_mfma_f32_32x32x16_bf16 v[192:207], v[56:59], v[44:47], v[192:207]
  ds_read_b64_tr_b16 v[54:55], v147 offset:13312
  v_exp_f32 v108, v108
  v_exp_f32 v109, v109
  v_exp_f32 v110, v110
  v_exp_f32 v111, v111
  s_waitcnt vmcnt(2) lgkmcnt(4)
  ds_read_b64_tr_b16 v[56:57], v146 offset:16384
  ds_read_b64_tr_b16 v[58:59], v146 offset:17408
  ds_read_b64_tr_b16 v[60:61], v147 offset:16384
  ds_read_b64_tr_b16 v[62:63], v147 offset:17408
  v_mfma_f32_32x32x16_bf16 v[208:223], v[68:71], v[16:19], v[208:223]
  s_waitcnt vmcnt(1) lgkmcnt(4)
  v_mfma_f32_32x32x16_bf16 v[208:223], v[52:55], v[20:23], v[208:223]
  s_waitcnt vmcnt(0) lgkmcnt(0)
  v_mfma_f32_32x32x16_bf16 v[208:223], v[60:63], v[24:27], v[208:223]
  v_mfma_f32_32x32x16_bf16 v[192:207], v[64:67], v[16:19], v[192:207]
  v_add_f32 v104, 1.0, v104
  v_add_f32 v105, 1.0, v105
  v_add_f32 v106, 1.0, v106
  v_add_f32 v107, 1.0, v107
  v_add_f32 v108, 1.0, v108
  v_add_f32 v109, 1.0, v109
  v_add_f32 v110, 1.0, v110
  v_add_f32 v111, 1.0, v111
  v_mfma_f32_32x32x16_bf16 v[192:207], v[48:51], v[20:23], v[192:207]
  v_rcp_f32 v104, v104
  v_rcp_f32 v105, v105
  v_rcp_f32 v106, v106
  v_rcp_f32 v107, v107
  v_rcp_f32 v108, v108
  v_rcp_f32 v109, v109
  v_rcp_f32 v110, v110
  v_rcp_f32 v111, v111
  ds_write_b128 v151, v[208:211] offset:16384
  ds_write_b128 v151, v[212:215] offset:17408
  ds_write_b128 v151, v[216:219] offset:18432
  ds_write_b128 v151, v[220:223] offset:19456
  v_mov_b32 v9, 1
  ds_write_b32 v157, v9 offset:12
  v_mfma_f32_32x32x16_bf16 v[192:207], v[56:59], v[24:27], v[192:207]
  v_mul_f32 v120, v120, v104
  v_mul_f32 v121, v121, v105
  v_mul_f32 v122, v122, v106
  v_mul_f32 v123, v123, v107
  v_mul_f32 v124, v124, v108
  v_mul_f32 v125, v125, v109
  v_mul_f32 v126, v126, v110
  v_mul_f32 v127, v127, v111
  ds_read_b32 v159, v156 offset:12
  ds_read_b128 v[96:99], v152 offset:16384
  ds_read_b128 v[100:103], v152 offset:17408
  ds_read_b128 v[104:107], v152 offset:18432
  ds_read_b128 v[108:111], v152 offset:19456
  v_pk_fma_f32 v[240:241], v[192:193], v[112:113], v[240:241]
  v_pk_fma_f32 v[242:243], v[194:195], v[114:115], v[242:243]
  v_pk_fma_f32 v[244:245], v[196:197], v[116:117], v[244:245]
  v_pk_fma_f32 v[246:247], v[198:199], v[118:119], v[246:247]
  v_pk_fma_f32 v[248:249], v[200:201], v[120:121], v[248:249]
  v_pk_fma_f32 v[250:251], v[202:203], v[122:123], v[250:251]
  v_pk_fma_f32 v[252:253], v[204:205], v[124:125], v[252:253]
  v_pk_fma_f32 v[254:255], v[206:207], v[126:127], v[254:255]
  s_waitcnt lgkmcnt(0)
  v_cmp_gt_u32 vcc, 1, v159
  s_cbranch_vccnz Llc_83
Llcok_84:
  v_pk_fma_f32 v[240:241], v[96:97], v[112:113], v[240:241]
  v_pk_fma_f32 v[242:243], v[98:99], v[114:115], v[242:243]
  v_pk_fma_f32 v[244:245], v[100:101], v[116:117], v[244:245]
  v_pk_fma_f32 v[246:247], v[102:103], v[118:119], v[246:247]
  v_cvt_pk_bf16_f32 v136, v240, v241
  v_cvt_pk_bf16_f32 v137, v242, v243
  v_cvt_pk_bf16_f32 v138, v244, v245
  v_cvt_pk_bf16_f32 v139, v246, v247
  s_nop 0
  v_permlane32_swap_b32 v136, v138
  v_permlane32_swap_b32 v137, v139
  buffer_store_dwordx4 v[136:139], v153, s[52:55], 0 offen offset:0
  v_pk_fma_f32 v[248:249], v[104:105], v[120:121], v[248:249]
  v_pk_fma_f32 v[250:251], v[106:107], v[122:123], v[250:251]
  v_pk_fma_f32 v[252:253], v[108:109], v[124:125], v[252:253]
  v_pk_fma_f32 v[254:255], v[110:111], v[126:127], v[254:255]
  v_cvt_pk_bf16_f32 v140, v248, v249
  v_cvt_pk_bf16_f32 v141, v250, v251
  v_cvt_pk_bf16_f32 v142, v252, v253
  v_cvt_pk_bf16_f32 v143, v254, v255
  s_nop 0
  v_permlane32_swap_b32 v140, v142
  v_permlane32_swap_b32 v141, v143
  buffer_store_dwordx4 v[140:143], v153, s[52:55], 0 offen offset:32
L_end:
  s_endpgm
Lnonce_16:
  s_mov_b32 s84, 0
Lnoncex_18:
  buffer_load_dword v93, v126, s[48:51], 0 offen sc1
  s_add_u32 s84, s84, 1
  s_waitcnt vmcnt(0)
  v_readfirstlane_b32 s73, v93
  s_cmp_gt_u32 s84, 262144
  s_cbranch_scc1 Lnonceok_17
  s_cmp_eq_u32 s73, 0
  s_cbranch_scc1 Lnoncex_18
  s_branch Lnonceok_17
Lst_19:
  s_mov_b32 s84, 0
Lstx_21:
  buffer_load_dwordx4 v[100:103], v125, s[44:47], 0 offen sc1
  buffer_load_dwordx4 v[104:107], v125, s[44:47], 0 offen offset:1024 sc1
  s_add_u32 s84, s84, 1
  s_cmp_gt_u32 s84, 262144
  s_waitcnt vmcnt(0)
  s_cbranch_scc1 Lstok_20
  v_cmp_ne_u32 vcc, s73, v103
  v_cmp_ne_u32 s[86:87], s73, v107
  s_nop 0
  s_or_b64 vcc, vcc, s[86:87]
  s_cbranch_vccnz Lstx_21
  s_branch Lstok_20
Lkf_24:
  s_mov_b32 s84, 0
  s_mov_b64 exec, 0xffff
Lkfx_26:
  buffer_load_dword v11, v0, s[44:47], s27 offen sc1
  s_add_u32 s84, s84, 1
  s_cmp_gt_u32 s84, 262144
  s_waitcnt vmcnt(0)
  s_cbranch_scc1 Lkfy_27
  v_cmp_ne_u32 vcc, s73, v11
  s_nop 0
  s_and_b64 exec, exec, vcc
  s_cbranch_execnz Lkfx_26
Lkfy_27:
  s_mov_b64 exec, -1
  s_branch Lkfok_25
Lgc_30:
  s_mov_b32 s84, 0
  s_mov_b64 exec, 0xffff
Lgcx_32:
  buffer_load_dword v158, v0, s[44:47], s81 offen sc1
  s_add_u32 s84, s84, 1
  s_cmp_gt_u32 s84, 262144
  s_waitcnt vmcnt(0)
  s_cbranch_scc1 Lgcy_33
  v_cmp_ne_u32 vcc, s73, v158
  s_nop 0
  s_and_b64 exec, exec, vcc
  s_cbranch_execnz Lgcx_32
Lgcy_33:
  s_mov_b64 exec, -1
  s_branch Lgcok_31
Leb_34:
  s_mov_b32 s84, 0
Lebx_36:
  ds_read_b32 v159, v154
  s_add_u32 s84, s84, 1
  s_cmp_gt_u32 s84, 2097152
  s_waitcnt lgkmcnt(0)
  s_cbranch_scc1 Lebok_35
  v_cmp_gt_u32 vcc, 1, v159
  s_cbranch_vccnz Lebx_36
  s_branch Lebok_35
Lnonce_37:
  s_mov_b32 s84, 0
Lnoncex_39:
  buffer_load_dword v93, v126, s[48:51], 0 offen sc1
  s_add_u32 s84, s84, 1
  s_waitcnt vmcnt(0)
  v_readfirstlane_b32 s73, v93
  s_cmp_gt_u32 s84, 262144
  s_cbranch_scc1 Lnonceok_38
  s_cmp_eq_u32 s73, 0
  s_cbranch_scc1 Lnoncex_39
  s_branch Lnonceok_38
Lst_40:
  s_mov_b32 s84, 0
Lstx_42:
  buffer_load_dwordx4 v[100:103], v125, s[44:47], 0 offen sc1
  buffer_load_dwordx4 v[104:107], v125, s[44:47], 0 offen offset:1024 sc1
  s_add_u32 s84, s84, 1
  s_cmp_gt_u32 s84, 262144
  s_waitcnt vmcnt(0)
  s_cbranch_scc1 Lstok_41
  v_cmp_ne_u32 vcc, s73, v103
  v_cmp_ne_u32 s[86:87], s73, v107
  s_nop 0
  s_or_b64 vcc, vcc, s[86:87]
  s_cbranch_vccnz Lstx_42
  s_branch Lstok_41
Lgc_43:
  s_mov_b32 s84, 0
  s_mov_b64 exec, 0xffff
Lgcx_45:
  buffer_load_dword v158, v0, s[44:47], s81 offen sc1
  s_add_u32 s84, s84, 1
  s_cmp_gt_u32 s84, 262144
  s_waitcnt vmcnt(0)
  s_cbranch_scc1 Lgcy_46
  v_cmp_ne_u32 vcc, s73, v158
  s_nop 0
  s_and_b64 exec, exec, vcc
  s_cbranch_execnz Lgcx_45
Lgcy_46:
  s_mov_b64 exec, -1
  s_branch Lgcok_44
Leb_47:
  s_mov_b32 s84, 0
Lebx_49:
  ds_read_b32 v159, v154
  s_add_u32 s84, s84, 1
  s_cmp_gt_u32 s84, 2097152
  s_waitcnt lgkmcnt(0)
  s_cbranch_scc1 Lebok_48
  v_cmp_gt_u32 vcc, 1, v159
  s_cbranch_vccnz Lebx_49
  s_branch Lebok_48
Llc_50:
  s_mov_b32 s84, 0
Llcx_52:
  ds_read_b32 v159, v154 offset:0
  s_add_u32 s84, s84, 1
  s_cmp_gt_u32 s84, 2097152
  s_waitcnt lgkmcnt(0)
  s_cbranch_scc1 Llcok_51
  v_cmp_gt_u32 vcc, 2, v159
  s_cbranch_vccnz Llcx_52
  s_branch Llcok_51
Lgc_53:
  s_mov_b32 s84, 0
  s_mov_b64 exec, 0xffff
Lgcx_55:
  buffer_load_dword v158, v0, s[44:47], s81 offen sc1
  s_add_u32 s84, s84, 1
  s_cmp_gt_u32 s84, 262144
  s_waitcnt vmcnt(0)
  s_cbranch_scc1 Lgcy_56
  v_cmp_ne_u32 vcc, s73, v158
  s_nop 0
  s_and_b64 exec, exec, vcc
  s_cbranch_execnz Lgcx_55
Lgcy_56:
  s_mov_b64 exec, -1
  s_branch Lgcok_54
Llc_57:
  s_mov_b32 s84, 0
Llcx_59:
  ds_read_b32 v159, v154 offset:0
  s_add_u32 s84, s84, 1
  s_cmp_gt_u32 s84, 2097152
  s_waitcnt lgkmcnt(0)
  s_cbranch_scc1 Llcok_58
  v_cmp_gt_u32 vcc, 3, v159
  s_cbranch_vccnz Llcx_59
  s_branch Llcok_58
Lgc_60:
  s_mov_b32 s84, 0
  s_mov_b64 exec, 0xffff
Lgcx_62:
  buffer_load_dword v158, v0, s[44:47], s81 offen sc1
  s_add_u32 s84, s84, 1
  s_cmp_gt_u32 s84, 262144
  s_waitcnt vmcnt(0)
  s_cbranch_scc1 Lgcy_63
  v_cmp_ne_u32 vcc, s73, v158
  s_nop 0
  s_and_b64 exec, exec, vcc
  s_cbranch_execnz Lgcx_62
Lgcy_63:
  s_mov_b64 exec, -1
  s_branch Lgcok_61
Lgc_64:
  s_mov_b32 s84, 0
  s_mov_b64 exec, 0xffff
Lgcx_66:
  buffer_load_dword v158, v0, s[44:47], s82 offen sc1
  s_add_u32 s84, s84, 1
  s_cmp_gt_u32 s84, 262144
  s_waitcnt vmcnt(0)
  s_cbranch_scc1 Lgcy_67
  v_cmp_ne_u32 vcc, s73, v158
  s_nop 0
  s_and_b64 exec, exec, vcc
  s_cbranch_execnz Lgcx_66
Lgcy_67:
  s_mov_b64 exec, -1
  s_branch Lgcok_65
Llc_68:
  s_mov_b32 s84, 0
Llcx_70:
  ds_read_b32 v159, v154 offset:0
  s_add_u32 s84, s84, 1
  s_cmp_gt_u32 s84, 2097152
  s_waitcnt lgkmcnt(0)
  s_cbranch_scc1 Llcok_69
  v_cmp_gt_u32 vcc, 4, v159
  s_cbranch_vccnz Llcx_70
  s_branch Llcok_69
Llc_71:
  s_mov_b32 s84, 0
Llcx_73:
  ds_read_b32 v159, v154 offset:0
  s_add_u32 s84, s84, 1
  s_cmp_gt_u32 s84, 2097152
  s_waitcnt lgkmcnt(0)
  s_cbranch_scc1 Llcok_72
  v_cmp_gt_u32 vcc, 5, v159
  s_cbranch_vccnz Llcx_73
  s_branch Llcok_72
Llc_74:
  s_mov_b32 s84, 0
Llcx_76:
  ds_read_b32 v159, v154 offset:16
  s_add_u32 s84, s84, 1
  s_cmp_gt_u32 s84, 2097152
  s_waitcnt lgkmcnt(0)
  s_cbranch_scc1 Llcok_75
  v_cmp_gt_u32 vcc, 5, v159
  s_cbranch_vccnz Llcx_76
  s_branch Llcok_75
Llc_77:
  s_mov_b32 s84, 0
Llcx_79:
  ds_read_b32 v159, v156 offset:8
  ds_read_b128 v[96:99], v152 offset:0
  ds_read_b128 v[100:103], v152 offset:1024
  ds_read_b128 v[104:107], v152 offset:2048
  ds_read_b128 v[108:111], v152 offset:3072
  s_add_u32 s84, s84, 1
  s_cmp_gt_u32 s84, 2097152
  s_waitcnt lgkmcnt(0)
  s_cbranch_scc1 Llcok_78
  v_cmp_gt_u32 vcc, 1, v159
  s_cbranch_vccnz Llcx_79
  s_branch Llcok_78
Llc_80:
  s_mov_b32 s84, 0
Llcx_82:
  ds_read_b32 v159, v154 offset:0
  s_add_u32 s84, s84, 1
  s_cmp_gt_u32 s84, 2097152
  s_waitcnt lgkmcnt(0)
  s_cbranch_scc1 Llcok_81
  v_cmp_gt_u32 vcc, 6, v159
  s_cbranch_vccnz Llcx_82
  s_branch Llcok_81
Llc_83:
  s_mov_b32 s84, 0
Llcx_85:
  ds_read_b32 v159, v156 offset:12
  ds_read_b128 v[96:99], v152 offset:16384
  ds_read_b128 v[100:103], v152 offset:17408
  ds_read_b128 v[104:107], v152 offset:18432
  ds_read_b128 v[108:111], v152 offset:19456
  s_add_u32 s84, s84, 1
  s_cmp_gt_u32 s84, 2097152
  s_waitcnt lgkmcnt(0)
  s_cbranch_scc1 Llcok_84
  v_cmp_gt_u32 vcc, 1, v159
  s_cbranch_vccnz Llcx_85
  s_branch Llcok_84
L_last:
  s_endpgm

.section .rodata,"a"
.p2align 6
.amdhsa_kernel recurrent_scan__linear_attn_block__dense_activation_gelu__prompt_kernel
  .amdhsa_next_free_vgpr 256
  .amdhsa_next_free_sgpr 102
  .amdhsa_accum_offset 256
  .amdhsa_group_segment_fixed_size 0
  .amdhsa_kernarg_size 88
  .amdhsa_user_sgpr_count 2
  .amdhsa_user_sgpr_kernarg_segment_ptr 1
  .amdhsa_system_sgpr_workgroup_id_x 1
.end_amdhsa_kernel
```
